```python
import torch

def _softmax(x, axis=-1):
    return torch.softmax(x, dim=axis)
def _gelu(x):
    return torch.nn.functional.gelu(x, approximate="tanh")
def _silu(x):
    return torch.nn.functional.silu(x)
def _sigmoid(x):
    return torch.sigmoid(x)
def _layernorm(x, axis=-1, eps=1e-5):
    m = x.mean(dim=axis, keepdim=True)
    v = x.var(dim=axis, keepdim=True, unbiased=False)
    return (x - m) / torch.sqrt(v + eps)
def _scatter_add(tgt, idx, src, axis=0):
    return tgt.clone().index_add_(axis, idx, src)
def _segment_sum(src, seg, n):
    out = torch.zeros((n,) + src.shape[1:], dtype=src.dtype)
    return out.index_add_(0, seg, src)
def _pad(x, pw):
    flat = tuple(v for pair in reversed(pw) for v in pair)
    return torch.nn.functional.pad(x, flat)

kernel_name = 'gated_mix__ssm_conv_s4__linear_attn_block__prompt'

def setup_inputs():

    _w = (lambda a: (lambda t: t.to(torch.bfloat16) if t.is_floating_point() else t)(torch.as_tensor(a)))
    def _A_setup():
        B, L, D, N = 1, 2048, 640, 128
        A_re = -(lambda _x: torch.exp(torch.as_tensor(_x)))((lambda *s: torch.randn(*s, dtype=torch.bfloat16) * 3.2)(D, N))
        A_im = torch.pi * (lambda *s: torch.randn(*s, dtype=torch.bfloat16) * 0.05)(D, N)
        B_re = (lambda *s: torch.randn(*s, dtype=torch.bfloat16) * 0.2)(D, N)
        B_im = (lambda *s: torch.randn(*s, dtype=torch.bfloat16) * 0.2)(D, N)
        C_re = (lambda *s: torch.randn(*s, dtype=torch.bfloat16) * 0.2)(D, N)
        C_im = (lambda *s: torch.randn(*s, dtype=torch.bfloat16) * 0.2)(D, N)
        log_dt = (lambda *s: torch.randn(*s, dtype=torch.bfloat16) * 0.05)(D) * 0.5 - 4.0
        Dskip = (lambda *s: torch.randn(*s, dtype=torch.bfloat16) * 0.05)(D)
        return {
            "u": _w((lambda *s: torch.randn(*s, dtype=torch.bfloat16) * 0.05)(B, L, D)),
            "A_re": _w(A_re),
            "A_im": _w(A_im),
            "B_re": _w(B_re),
            "B_im": _w(B_im),
            "C_re": _w(C_re),
            "C_im": _w(C_im),
            "log_dt": _w(log_dt),
            "Dskip": _w(Dskip),
        }
    _A_in = _A_setup()

    def _B_setup():
        B, S, D = 1, 2048, 640
        return {
            "x": _w((lambda *s: torch.randn(*s, dtype=torch.bfloat16) * 0.05)(B, S, D)),
            "wqkv": _w((lambda *s: torch.randn(*s, dtype=torch.bfloat16) * 0.8)(D, 3 * D)),
            "wo": _w((lambda *s: torch.randn(*s, dtype=torch.bfloat16) * 0.05)(D, D)),
        }
    _B_in = _B_setup()

    return {
        "A_u": _A_in["u"],
        "A_A_re": _A_in["A_re"],
        "A_A_im": _A_in["A_im"],
        "A_B_re": _A_in["B_re"],
        "A_B_im": _A_in["B_im"],
        "A_C_re": _A_in["C_re"],
        "A_C_im": _A_in["C_im"],
        "A_log_dt": _A_in["log_dt"],
        "A_Dskip": _A_in["Dskip"],
        "B_x": _B_in["x"],
        "B_wqkv": _B_in["wqkv"],
        "B_wo": _B_in["wo"],
        "gate_w": _w((lambda *s: torch.randn(*s, dtype=torch.bfloat16) * 0.05)(640) * 16.0),
    }

def reference(A_u, A_A_re, A_A_im, A_B_re, A_B_im, A_C_re, A_C_im, A_log_dt, A_Dskip, B_x, B_wqkv, B_wo, gate_w):
    def _A_ref(u, A_re, A_im, B_re, B_im, C_re, C_im, log_dt, Dskip):
        Bsz, L, D = u.shape
        dt = torch.exp(log_dt)[:, None]
        A = A_re + 1j * A_im
        Bc = B_re + 1j * B_im
        Cc = C_re + 1j * C_im
        logdA = dt * A
        dB = dt * Bc
        l = (lambda x, dt: x.to(dt))(torch.arange(L), A_re.dtype)
        P = torch.exp(logdA[:, :, None] * l[None, None, :])
        K = torch.einsum("dn,dnl,dn->dl", Cc, P, dB).real
        L2 = 2 * L
        Kp = _pad(K, ((0, 0), (0, L)))
        up = (lambda x, *d: x.permute(*d))(u, 0, 2, 1)
        up = _pad(up, ((0, 0), (0, 0), (0, L)))
        Kf = (lambda x, axes=(-2,-1): torch.fft.rfft2(x.float(), dim=axes))(Kp[:, None, :], axes=(-2, -1))
        Uf = (lambda x, axes=(-2,-1): torch.fft.rfft2(x.float(), dim=axes))(up[:, :, None, :], axes=(-2, -1))
        Yf = Uf * Kf[None, :, :, :]
        y = (lambda x, s, axes=(-2,-1): torch.fft.irfft2(x, s=s, dim=axes).to(torch.bfloat16))(Yf, (1, L2), axes=(-2, -1))[:, :, 0, :L]
        y = (lambda x, *d: x.permute(*d))(y, 0, 2, 1) + u * Dskip[None, None, :]
        return y

    def _B_ref(x, wqkv, wo):
        B, S, D = x.shape
        H = 32; Dh = D // H
        qkv = (lambda x, *d: x.permute(*d))((x @ wqkv).reshape(B, S, 3, H, Dh), 2, 0, 3, 1, 4)
        q, k, v = qkv[0], qkv[1], qkv[2]
        phi = lambda t: torch.where(t > 0, t + 1, torch.exp(t)) + 1e-6
        pq, pk = phi(q), phi(k)
        kv = torch.einsum("bhsd,bhse->bhde", pk, v)
        z = torch.einsum("bhsd->bhd", pk)
        num = torch.einsum("bhqd,bhde->bhqe", pq, kv)
        den = torch.einsum("bhqd,bhd->bhq", pq, z)[..., None] + 1e-6
        o = num / den
        return (lambda x, *d: x.permute(*d))(o, 0, 2, 1, 3).reshape(B, S, D) @ wo

    x = A_u
    g = _sigmoid((x * gate_w).sum(-1, keepdims=True))
    a = _A_ref(x, A_A_re, A_A_im, A_B_re, A_B_im, A_C_re, A_C_im, A_log_dt, A_Dskip)
    b = _B_ref(x, B_wqkv, B_wo)
    return g * a + (1 - g) * b
```

```asm
; @launch kernel=gated_mix__ssm_conv_s4__linear_attn_block__prompt_kernel grid=(256,1,1) block=(512,1,1) lds=163840
; @launch kernel=attn_out_kernel grid=(256,1,1) block=(512,1,1) lds=139264
.amdgcn_target "amdgcn-amd-amdhsa--gfx950"
.text
.globl gated_mix__ssm_conv_s4__linear_attn_block__prompt_kernel
.p2align 8
.type gated_mix__ssm_conv_s4__linear_attn_block__prompt_kernel,@function
gated_mix__ssm_conv_s4__linear_attn_block__prompt_kernel:
    s_cmp_ge_u32 s2, 256
    s_cbranch_scc1 L_1_done
    s_cmp_ge_u32 s2, 128
    s_cbranch_scc1 L_conv
    s_mov_b32 s3, s2
L_gemm:
    s_load_dwordx2 s[4:5], s[0:1], 0
    s_load_dwordx4 s[8:11], s[0:1], 80
    s_load_dwordx2 s[20:21], s[0:1], 96
    s_load_dwordx4 s[32:35], s[0:1], 112
    s_and_b32 s22, s3, 7
    s_lshr_b32 s23, s3, 3
    s_lshr_b32 s28, s22, 1
    s_lshl_b32 s28, s28, 1
    s_and_b32 s29, s23, 1
    s_add_u32 s24, s28, s29
    s_and_b32 s28, s22, 1
    s_lshl_b32 s28, s28, 3
    s_lshr_b32 s29, s23, 1
    s_add_u32 s25, s28, s29
    v_lshrrev_b32 v18, 6, v0
    v_and_b32 v1, 63, v0
    v_readfirstlane_b32 s26, v18
    v_and_b32 v2, 15, v0
    v_lshrrev_b32 v3, 4, v1
    s_lshl_b32 s28, s24, 8
    s_lshl_b32 s29, s26, 5
    s_add_u32 s28, s28, s29
    v_lshrrev_b32 v18, 3, v1
    v_lshrrev_b32 v19, 1, v18
    v_and_b32 v20, 7, v1
    v_xor_b32 v19, v19, v20
    v_lshlrev_b32 v19, 4, v19
    v_add_u32 v18, s28, v18
    s_movk_i32 s29, 1280
    v_mad_u32_u24 v4, v18, s29, v19
    v_xor_b32 v7, 64, v4
    v_lshrrev_b32 v18, 1, v2
    v_xor_b32 v18, v18, v3
    v_lshlrev_b32 v18, 4, v18
    v_lshl_add_u32 v18, v2, 7, v18
    s_lshl_b32 s52, s26, 13
    s_add_u32 s52, s52, 65536
    v_add_u32 v5, s52, v18
    v_xor_b32 v6, 64, v5
    s_lshl_b32 s28, s26, 3
    v_add_u32 v18, s28, v3
    s_movk_i32 s29, 3840
    s_mul_i32 s30, s25, 80
    v_mul_u32_u24 v18, s29, v18
    v_add_u32 v18, s30, v18
    v_lshlrev_b32 v19, 1, v3
    v_sub_u32 v19, v2, v19
    v_subrev_u32 v19, s28, v19
    v_and_b32 v19, 15, v19
    v_mul_u32_u24 v20, 205, v19
    v_lshrrev_b32 v20, 10, v20
    v_mul_u32_u24 v21, 1200, v20
    v_lshl_add_u32 v21, v19, 4, v21
    v_add_u32 v8, v21, v18
    v_cmp_eq_u32 vcc, 15, v19
    v_mov_b32 v20, 0x40000000
    s_nop 0
    v_cndmask_b32 v8, v8, v20, vcc
    s_lshl_b32 s41, s26, 11
    s_and_b32 s28, s24, 1
    s_mul_i32 s28, s28, 5
    s_and_b32 s29, s25, 7
    s_add_u32 s28, s28, s29
    s_cmp_ge_u32 s28, 10
    s_cselect_b32 s29, 10, 0
    s_sub_u32 s28, s28, s29
    s_mul_i32 s36, s28, 245760
    s_lshl_b32 s56, s28, 7
    s_mov_b32 s54, 0
    s_mov_b32 s55, 0
    s_waitcnt lgkmcnt(0)
    s_mov_b32 s16, s10
    s_and_b32 s17, s11, 0xffff
    s_mov_b32 s18, 819200
    s_mov_b32 s19, 0x00020000
    s_and_b32 s5, s5, 0xffff
    s_mov_b32 s6, 2621440
    s_mov_b32 s7, 0x00020000
    s_and_b32 s9, s9, 0xffff
    s_mov_b32 s10, 2457600
    s_mov_b32 s11, 0x00020000
    s_mov_b32 s12, s34
    s_and_b32 s13, s35, 0xffff
    s_mov_b32 s14, 13631488
    s_mov_b32 s15, 0x00020000
    s_mov_b32 s42, 0x3fb8aa3b
    s_mov_b32 s43, 0x358637bd
    s_or_b32 s28, s24, s26
    s_cmp_lg_u32 s28, 0
    s_cbranch_scc1 L_g_nozero
    v_mov_b32 v92, 0
    v_mov_b32 v93, 0
    v_mov_b32 v94, 0
    v_mov_b32 v95, 0
    v_lshlrev_b32 v18, 4, v1
    s_mul_i32 s28, s25, 5120
    buffer_store_dwordx4 v[92:95], v18, s[12:15], s28 offen offset:0 sc1
    buffer_store_dwordx4 v[92:95], v18, s[12:15], s28 offen offset:1024 sc1
    buffer_store_dwordx4 v[92:95], v18, s[12:15], s28 offen offset:2048 sc1
    buffer_store_dwordx4 v[92:95], v18, s[12:15], s28 offen offset:3072 sc1
    s_add_u32 s28, s28, 4096
    buffer_store_dwordx4 v[92:95], v18, s[12:15], s28 offen sc1
L_g_nozero:
    v_add_u32 v192, 0, v8
    v_add_u32 v206, 0, v4
    v_add_u32 v193, 14336, v8
    v_add_u32 v207, 9216, v7
    v_add_u32 v208, 18432, v4
    v_add_u32 v209, 27648, v7
    s_cmp_lt_u32 s54, 10
    s_cselect_b32 s58, s36, 0x40000000
    s_add_u32 s36, s36, 245760
    s_cmp_eq_u32 s36, 2457600
    s_cselect_b32 s36, 0, s36
    s_add_u32 s54, s54, 1
    s_add_u32 m0, s41, 0
    s_nop 0
    buffer_load_dwordx4 v192, s[8:11], s58 offen offset:0 lds
    buffer_load_dwordx4 v193, s[8:11], s58 offen offset:1024 lds
    s_cmp_lt_u32 s55, 10
    s_cselect_b32 s60, s56, 0x40000000
    s_add_u32 s56, s56, 128
    s_cmp_eq_u32 s56, 1280
    s_cselect_b32 s56, 0, s56
    s_add_u32 s55, s55, 1
    s_add_u32 m0, s52, 0
    s_nop 0
    buffer_load_dwordx4 v206, s[4:7], s60 offen offset:0 lds
    buffer_load_dwordx4 v207, s[4:7], s60 offen offset:1024 lds
    buffer_load_dwordx4 v208, s[4:7], s60 offen offset:2048 lds
    buffer_load_dwordx4 v209, s[4:7], s60 offen offset:3072 lds
    v_lshrrev_b32 v18, 2, v2
    v_and_b32 v19, 1, v3
    v_lshl_add_u32 v19, v19, 2, v18
    v_lshlrev_b32 v19, 1, v19
    v_lshl_add_u32 v20, v3, 3, v18
    v_lshlrev_b32 v20, 8, v20
    v_and_b32 v21, 3, v2
    v_lshlrev_b32 v21, 3, v21
    s_mov_b32 s28, 0x3020100
    v_bfe_u32 v22, s28, v21, 8
    v_lshrrev_b32 v23, 1, v22
    v_add_u32 v23, v23, v19
    v_and_b32 v23, 15, v23
    v_lshl_add_u32 v23, v23, 4, v20
    v_and_b32 v22, 1, v22
    v_lshl_add_u32 v10, v22, 3, v23
    s_mov_b32 s28, 0x6050403
    v_bfe_u32 v22, s28, v21, 8
    v_lshrrev_b32 v23, 1, v22
    v_add_u32 v23, v23, v19
    v_and_b32 v23, 15, v23
    v_lshl_add_u32 v23, v23, 4, v20
    v_and_b32 v22, 1, v22
    v_lshl_add_u32 v11, v22, 3, v23
    s_mov_b32 s28, 0x9080706
    v_bfe_u32 v22, s28, v21, 8
    v_lshrrev_b32 v23, 1, v22
    v_add_u32 v23, v23, v19
    v_and_b32 v23, 15, v23
    v_lshl_add_u32 v23, v23, 4, v20
    v_and_b32 v22, 1, v22
    v_lshl_add_u32 v12, v22, 3, v23
    s_mov_b32 s28, 0xd0c0b0a
    v_bfe_u32 v22, s28, v21, 8
    v_lshrrev_b32 v23, 1, v22
    v_add_u32 v23, v23, v19
    v_and_b32 v23, 15, v23
    v_lshl_add_u32 v23, v23, 4, v20
    v_and_b32 v22, 1, v22
    v_lshl_add_u32 v13, v22, 3, v23
    s_mov_b32 s28, 0x1211100f
    v_bfe_u32 v22, s28, v21, 8
    v_lshrrev_b32 v23, 1, v22
    v_add_u32 v23, v23, v19
    v_and_b32 v23, 15, v23
    v_lshl_add_u32 v23, v23, 4, v20
    v_and_b32 v22, 1, v22
    v_lshl_add_u32 v14, v22, 3, v23
    s_mov_b32 s28, 0x1d18130e
    v_bfe_u32 v22, s28, v21, 8
    v_lshrrev_b32 v23, 1, v22
    v_add_u32 v23, v23, v19
    v_and_b32 v23, 15, v23
    v_lshl_add_u32 v23, v23, 4, v20
    v_and_b32 v22, 1, v22
    v_lshl_add_u32 v15, v22, 3, v23
    s_mov_b32 s28, 0x17161514
    v_bfe_u32 v22, s28, v21, 8
    v_lshrrev_b32 v23, 1, v22
    v_add_u32 v23, v23, v19
    v_and_b32 v23, 15, v23
    v_lshl_add_u32 v23, v23, 4, v20
    v_and_b32 v22, 1, v22
    v_lshl_add_u32 v16, v22, 3, v23
    s_mov_b32 s28, 0x1c1b1a19
    v_bfe_u32 v22, s28, v21, 8
    v_lshrrev_b32 v23, 1, v22
    v_add_u32 v23, v23, v19
    v_and_b32 v23, 15, v23
    v_lshl_add_u32 v23, v23, 4, v20
    v_and_b32 v22, 1, v22
    v_lshl_add_u32 v17, v22, 3, v23
    v_mov_b32 v28, 0
    v_mov_b32 v29, 0
    v_mov_b32 v30, 0
    v_mov_b32 v31, 0
    v_mov_b32 v32, 0
    v_mov_b32 v33, 0
    v_mov_b32 v34, 0
    v_mov_b32 v35, 0
    v_mov_b32 v36, 0
    v_mov_b32 v37, 0
    v_mov_b32 v38, 0
    v_mov_b32 v39, 0
    v_mov_b32 v40, 0
    v_mov_b32 v41, 0
    v_mov_b32 v42, 0
    v_mov_b32 v43, 0
    v_mov_b32 v44, 0
    v_mov_b32 v45, 0
    v_mov_b32 v46, 0
    v_mov_b32 v47, 0
    v_mov_b32 v48, 0
    v_mov_b32 v49, 0
    v_mov_b32 v50, 0
    v_mov_b32 v51, 0
    v_mov_b32 v52, 0
    v_mov_b32 v53, 0
    v_mov_b32 v54, 0
    v_mov_b32 v55, 0
    v_mov_b32 v56, 0
    v_mov_b32 v57, 0
    v_mov_b32 v58, 0
    v_mov_b32 v59, 0
    v_mov_b32 v60, 0
    v_mov_b32 v61, 0
    v_mov_b32 v62, 0
    v_mov_b32 v63, 0
    v_mov_b32 v64, 0
    v_mov_b32 v65, 0
    v_mov_b32 v66, 0
    v_mov_b32 v67, 0
    v_mov_b32 v68, 0
    v_mov_b32 v69, 0
    v_mov_b32 v70, 0
    v_mov_b32 v71, 0
    v_mov_b32 v72, 0
    v_mov_b32 v73, 0
    v_mov_b32 v74, 0
    v_mov_b32 v75, 0
    v_mov_b32 v76, 0
    v_mov_b32 v77, 0
    v_mov_b32 v78, 0
    v_mov_b32 v79, 0
    v_mov_b32 v80, 0
    v_mov_b32 v81, 0
    v_mov_b32 v82, 0
    v_mov_b32 v83, 0
    v_mov_b32 v84, 0
    v_mov_b32 v85, 0
    v_mov_b32 v86, 0
    v_mov_b32 v87, 0
    v_mov_b32 v88, 0
    v_mov_b32 v89, 0
    v_mov_b32 v90, 0
    v_mov_b32 v91, 0
    s_cmp_lt_u32 s54, 10
    s_cselect_b32 s58, s36, 0x40000000
    s_add_u32 s36, s36, 245760
    s_cmp_eq_u32 s36, 2457600
    s_cselect_b32 s36, 0, s36
    s_add_u32 s54, s54, 1
    s_add_u32 m0, s41, 16384
    s_nop 0
    buffer_load_dwordx4 v192, s[8:11], s58 offen offset:0 lds
    buffer_load_dwordx4 v193, s[8:11], s58 offen offset:1024 lds
    s_cmp_lt_u32 s55, 10
    s_cselect_b32 s60, s56, 0x40000000
    s_add_u32 s56, s56, 128
    s_cmp_eq_u32 s56, 1280
    s_cselect_b32 s56, 0, s56
    s_add_u32 s55, s55, 1
    s_add_u32 m0, s52, 4096
    s_nop 0
    buffer_load_dwordx4 v206, s[4:7], s60 offen offset:0 lds
    buffer_load_dwordx4 v207, s[4:7], s60 offen offset:1024 lds
    buffer_load_dwordx4 v208, s[4:7], s60 offen offset:2048 lds
    buffer_load_dwordx4 v209, s[4:7], s60 offen offset:3072 lds
    s_movk_i32 s29, 1280
    s_waitcnt vmcnt(6)
    s_barrier
    s_or_b32 s28, s24, s26
    s_cmp_lg_u32 s28, 0
    s_cbranch_scc1 L_g_noflag
    s_lshl_b32 s28, s25, 2
    v_mov_b32 v18, s28
    v_mov_b32 v19, 1
    s_mov_b64 exec, 1
    global_atomic_add v18, v19, s[32:33]
    s_mov_b64 exec, -1
L_g_noflag:
    ds_read_b128 v[124:127], v5 offset:0
    ds_read_b128 v[128:131], v5 offset:2048
    ds_read_b128 v[132:135], v6 offset:0
    ds_read_b128 v[136:139], v6 offset:2048
    ds_read_b64_tr_b16 v[92:93], v10 offset:0
    ds_read_b64_tr_b16 v[94:95], v10 offset:1024
    ds_read_b64_tr_b16 v[96:97], v11 offset:0
    ds_read_b64_tr_b16 v[98:99], v11 offset:1024
    ds_read_b64_tr_b16 v[100:101], v12 offset:0
    ds_read_b64_tr_b16 v[102:103], v12 offset:1024
    ds_read_b64_tr_b16 v[104:105], v13 offset:0
    ds_read_b64_tr_b16 v[106:107], v13 offset:1024
    ds_read_b64_tr_b16 v[108:109], v14 offset:0
    ds_read_b64_tr_b16 v[110:111], v14 offset:1024
    ds_read_b64_tr_b16 v[112:113], v15 offset:0
    ds_read_b64_tr_b16 v[114:115], v15 offset:1024
    ds_read_b64_tr_b16 v[116:117], v16 offset:0
    ds_read_b64_tr_b16 v[118:119], v16 offset:1024
    s_cmp_lt_u32 s54, 10
    s_cselect_b32 s58, s36, 0x40000000
    s_add_u32 s36, s36, 245760
    s_cmp_eq_u32 s36, 2457600
    s_cselect_b32 s36, 0, s36
    s_add_u32 s54, s54, 1
    s_add_u32 m0, s41, 32768
    s_nop 0
    buffer_load_dwordx4 v192, s[8:11], s58 offen offset:0 lds
    buffer_load_dwordx4 v193, s[8:11], s58 offen offset:1024 lds
    s_cmp_lt_u32 s54, 10
    s_cselect_b32 s58, s36, 0x40000000
    s_add_u32 s36, s36, 245760
    s_cmp_eq_u32 s36, 2457600
    s_cselect_b32 s36, 0, s36
    s_add_u32 s54, s54, 1
    s_add_u32 m0, s41, 49152
    s_nop 0
    buffer_load_dwordx4 v192, s[8:11], s58 offen offset:0 lds
    buffer_load_dwordx4 v193, s[8:11], s58 offen offset:1024 lds
    s_mov_b32 s37, 0
    s_mov_b32 s40, 0
    s_lshl_b32 s28, s25, 2
    v_mov_b32 v9, s28
    s_cmp_eq_u32 s26, 0
    s_cselect_b32 s38, 3, 99
L_g_loop:
    s_waitcnt lgkmcnt(10)
    v_mfma_f32_16x16x32_bf16 v[28:31], v[92:95], v[124:127], v[28:31]
    ds_read_b64_tr_b16 v[120:121], v17 offset:0
    s_cmp_lt_u32 s55, 10
    s_cselect_b32 s60, s56, 0x40000000
    v_mfma_f32_16x16x32_bf16 v[32:35], v[92:95], v[128:131], v[32:35]
    ds_read_b64_tr_b16 v[122:123], v17 offset:1024
    s_add_u32 s56, s56, 128
    s_cmp_eq_u32 s56, 1280
    v_mfma_f32_16x16x32_bf16 v[36:39], v[96:99], v[124:127], v[36:39]
    ds_read_b64_tr_b16 v[92:93], v10 offset:8192
    s_cselect_b32 s56, 0, s56
    s_add_u32 s55, s55, 1
    v_mfma_f32_16x16x32_bf16 v[40:43], v[96:99], v[128:131], v[40:43]
    ds_read_b64_tr_b16 v[94:95], v10 offset:9216
    s_add_u32 m0, s52, 0
    s_waitcnt lgkmcnt(10)
    v_mfma_f32_16x16x32_bf16 v[44:47], v[100:103], v[124:127], v[44:47]
    ds_read_b64_tr_b16 v[96:97], v11 offset:8192
    v_mfma_f32_16x16x32_bf16 v[48:51], v[100:103], v[128:131], v[48:51]
    ds_read_b64_tr_b16 v[98:99], v11 offset:9216
    buffer_load_dwordx4 v206, s[4:7], s60 offen offset:0 lds
    v_mfma_f32_16x16x32_bf16 v[52:55], v[124:127], v[104:107], v[52:55]
    ds_read_b64_tr_b16 v[100:101], v12 offset:8192
    v_mfma_f32_16x16x32_bf16 v[56:59], v[128:131], v[104:107], v[56:59]
    ds_read_b64_tr_b16 v[102:103], v12 offset:9216
    s_waitcnt lgkmcnt(10)
    v_mfma_f32_16x16x32_bf16 v[60:63], v[124:127], v[108:111], v[60:63]
    ds_read_b64_tr_b16 v[104:105], v13 offset:8192
    buffer_load_dwordx4 v207, s[4:7], s60 offen offset:1024 lds
    v_mfma_f32_16x16x32_bf16 v[64:67], v[128:131], v[108:111], v[64:67]
    ds_read_b64_tr_b16 v[106:107], v13 offset:9216
    v_mfma_f32_16x16x32_bf16 v[68:71], v[124:127], v[112:115], v[68:71]
    ds_read_b64_tr_b16 v[108:109], v14 offset:8192
    v_mfma_f32_16x16x32_bf16 v[72:75], v[128:131], v[112:115], v[72:75]
    ds_read_b64_tr_b16 v[110:111], v14 offset:9216
    buffer_load_dwordx4 v208, s[4:7], s60 offen offset:2048 lds
    s_waitcnt lgkmcnt(10)
    v_mfma_f32_16x16x32_bf16 v[76:79], v[124:127], v[116:119], v[76:79]
    ds_read_b64_tr_b16 v[112:113], v15 offset:8192
    v_mfma_f32_16x16x32_bf16 v[80:83], v[128:131], v[116:119], v[80:83]
    ds_read_b64_tr_b16 v[114:115], v15 offset:9216
    v_mfma_f32_16x16x32_bf16 v[84:87], v[124:127], v[120:123], v[84:87]
    ds_read_b64_tr_b16 v[116:117], v16 offset:8192
    buffer_load_dwordx4 v209, s[4:7], s60 offen offset:3072 lds
    v_mfma_f32_16x16x32_bf16 v[88:91], v[128:131], v[120:123], v[88:91]
    ds_read_b64_tr_b16 v[118:119], v16 offset:9216
    s_waitcnt lgkmcnt(10)
    v_mfma_f32_16x16x32_bf16 v[28:31], v[92:95], v[132:135], v[28:31]
    ds_read_b64_tr_b16 v[120:121], v17 offset:8192
    s_cmp_lt_u32 s54, 10
    s_cselect_b32 s58, s36, 0x40000000
    v_mfma_f32_16x16x32_bf16 v[32:35], v[92:95], v[136:139], v[32:35]
    ds_read_b64_tr_b16 v[122:123], v17 offset:9216
    s_add_u32 s36, s36, 245760
    s_cmp_eq_u32 s36, 2457600
    v_mfma_f32_16x16x32_bf16 v[36:39], v[96:99], v[132:135], v[36:39]
    s_cselect_b32 s36, 0, s36
    s_add_u32 s54, s54, 1
    v_mfma_f32_16x16x32_bf16 v[40:43], v[96:99], v[136:139], v[40:43]
    s_add_u32 m0, s41, s37
    s_waitcnt lgkmcnt(8)
    v_mfma_f32_16x16x32_bf16 v[44:47], v[100:103], v[132:135], v[44:47]
    s_add_u32 s37, s37, 16384
    v_mfma_f32_16x16x32_bf16 v[48:51], v[100:103], v[136:139], v[48:51]
    s_and_b32 s37, s37, 0xffff
    s_waitcnt vmcnt(6) lgkmcnt(0)
    s_barrier
    v_mfma_f32_16x16x32_bf16 v[52:55], v[132:135], v[104:107], v[52:55]
    ds_read_b128 v[140:143], v5 offset:4096
    ds_read_b128 v[144:147], v5 offset:6144
    v_mfma_f32_16x16x32_bf16 v[56:59], v[136:139], v[104:107], v[56:59]
    ds_read_b128 v[148:151], v6 offset:4096
    ds_read_b128 v[152:155], v6 offset:6144
    v_mfma_f32_16x16x32_bf16 v[60:63], v[132:135], v[108:111], v[60:63]
    buffer_load_dwordx4 v192, s[8:11], s58 offen offset:0 lds
    ds_read_b64_tr_b16 v[92:93], v10 offset:16384
    ds_read_b64_tr_b16 v[94:95], v10 offset:17408
    v_mfma_f32_16x16x32_bf16 v[64:67], v[136:139], v[108:111], v[64:67]
    ds_read_b64_tr_b16 v[96:97], v11 offset:16384
    ds_read_b64_tr_b16 v[98:99], v11 offset:17408
    v_mfma_f32_16x16x32_bf16 v[68:71], v[132:135], v[112:115], v[68:71]
    ds_read_b64_tr_b16 v[100:101], v12 offset:16384
    ds_read_b64_tr_b16 v[102:103], v12 offset:17408
    v_mfma_f32_16x16x32_bf16 v[72:75], v[136:139], v[112:115], v[72:75]
    ds_read_b64_tr_b16 v[104:105], v13 offset:16384
    ds_read_b64_tr_b16 v[106:107], v13 offset:17408
    v_mfma_f32_16x16x32_bf16 v[76:79], v[132:135], v[116:119], v[76:79]
    buffer_load_dwordx4 v193, s[8:11], s58 offen offset:1024 lds
    ds_read_b64_tr_b16 v[108:109], v14 offset:16384
    ds_read_b64_tr_b16 v[110:111], v14 offset:17408
    v_mfma_f32_16x16x32_bf16 v[80:83], v[136:139], v[116:119], v[80:83]
    ds_read_b64_tr_b16 v[112:113], v15 offset:16384
    ds_read_b64_tr_b16 v[114:115], v15 offset:17408
    v_mfma_f32_16x16x32_bf16 v[84:87], v[132:135], v[120:123], v[84:87]
    ds_read_b64_tr_b16 v[116:117], v16 offset:16384
    ds_read_b64_tr_b16 v[118:119], v16 offset:17408
    v_mfma_f32_16x16x32_bf16 v[88:91], v[136:139], v[120:123], v[88:91]
    s_waitcnt lgkmcnt(10)
    v_mfma_f32_16x16x32_bf16 v[28:31], v[92:95], v[140:143], v[28:31]
    ds_read_b64_tr_b16 v[120:121], v17 offset:16384
    s_cmp_lt_u32 s55, 10
    s_cselect_b32 s60, s56, 0x40000000
    v_mfma_f32_16x16x32_bf16 v[32:35], v[92:95], v[144:147], v[32:35]
    ds_read_b64_tr_b16 v[122:123], v17 offset:17408
    s_add_u32 s56, s56, 128
    s_cmp_eq_u32 s56, 1280
    v_mfma_f32_16x16x32_bf16 v[36:39], v[96:99], v[140:143], v[36:39]
    ds_read_b64_tr_b16 v[92:93], v10 offset:24576
    s_cselect_b32 s56, 0, s56
    s_add_u32 s55, s55, 1
    v_mfma_f32_16x16x32_bf16 v[40:43], v[96:99], v[144:147], v[40:43]
    ds_read_b64_tr_b16 v[94:95], v10 offset:25600
    s_add_u32 m0, s52, 4096
    s_waitcnt lgkmcnt(10)
    v_mfma_f32_16x16x32_bf16 v[44:47], v[100:103], v[140:143], v[44:47]
    ds_read_b64_tr_b16 v[96:97], v11 offset:24576
    v_mfma_f32_16x16x32_bf16 v[48:51], v[100:103], v[144:147], v[48:51]
    ds_read_b64_tr_b16 v[98:99], v11 offset:25600
    buffer_load_dwordx4 v206, s[4:7], s60 offen offset:0 lds
    v_mfma_f32_16x16x32_bf16 v[52:55], v[140:143], v[104:107], v[52:55]
    ds_read_b64_tr_b16 v[100:101], v12 offset:24576
    v_mfma_f32_16x16x32_bf16 v[56:59], v[144:147], v[104:107], v[56:59]
    ds_read_b64_tr_b16 v[102:103], v12 offset:25600
    s_waitcnt lgkmcnt(10)
    v_mfma_f32_16x16x32_bf16 v[60:63], v[140:143], v[108:111], v[60:63]
    ds_read_b64_tr_b16 v[104:105], v13 offset:24576
    buffer_load_dwordx4 v207, s[4:7], s60 offen offset:1024 lds
    v_mfma_f32_16x16x32_bf16 v[64:67], v[144:147], v[108:111], v[64:67]
    ds_read_b64_tr_b16 v[106:107], v13 offset:25600
    v_mfma_f32_16x16x32_bf16 v[68:71], v[140:143], v[112:115], v[68:71]
    ds_read_b64_tr_b16 v[108:109], v14 offset:24576
    v_mfma_f32_16x16x32_bf16 v[72:75], v[144:147], v[112:115], v[72:75]
    ds_read_b64_tr_b16 v[110:111], v14 offset:25600
    buffer_load_dwordx4 v208, s[4:7], s60 offen offset:2048 lds
    s_waitcnt lgkmcnt(10)
    v_mfma_f32_16x16x32_bf16 v[76:79], v[140:143], v[116:119], v[76:79]
    ds_read_b64_tr_b16 v[112:113], v15 offset:24576
    v_mfma_f32_16x16x32_bf16 v[80:83], v[144:147], v[116:119], v[80:83]
    ds_read_b64_tr_b16 v[114:115], v15 offset:25600
    v_mfma_f32_16x16x32_bf16 v[84:87], v[140:143], v[120:123], v[84:87]
    ds_read_b64_tr_b16 v[116:117], v16 offset:24576
    buffer_load_dwordx4 v209, s[4:7], s60 offen offset:3072 lds
    v_mfma_f32_16x16x32_bf16 v[88:91], v[144:147], v[120:123], v[88:91]
    ds_read_b64_tr_b16 v[118:119], v16 offset:25600
    s_waitcnt lgkmcnt(10)
    v_mfma_f32_16x16x32_bf16 v[28:31], v[92:95], v[148:151], v[28:31]
    ds_read_b64_tr_b16 v[120:121], v17 offset:24576
    s_cmp_lt_u32 s54, 10
    s_cselect_b32 s58, s36, 0x40000000
    v_mfma_f32_16x16x32_bf16 v[32:35], v[92:95], v[152:155], v[32:35]
    ds_read_b64_tr_b16 v[122:123], v17 offset:25600
    s_add_u32 s36, s36, 245760
    s_cmp_eq_u32 s36, 2457600
    v_mfma_f32_16x16x32_bf16 v[36:39], v[96:99], v[148:151], v[36:39]
    s_cselect_b32 s36, 0, s36
    s_add_u32 s54, s54, 1
    v_xor_b32 v10, 0x8000, v10
    v_xor_b32 v11, 0x8000, v11
    v_mfma_f32_16x16x32_bf16 v[40:43], v[96:99], v[152:155], v[40:43]
    s_add_u32 m0, s41, s37
    v_xor_b32 v12, 0x8000, v12
    v_xor_b32 v13, 0x8000, v13
    s_waitcnt lgkmcnt(8)
    v_mfma_f32_16x16x32_bf16 v[44:47], v[100:103], v[148:151], v[44:47]
    v_xor_b32 v14, 0x8000, v14
    v_xor_b32 v15, 0x8000, v15
    s_add_u32 s37, s37, 16384
    v_mfma_f32_16x16x32_bf16 v[48:51], v[100:103], v[152:155], v[48:51]
    v_xor_b32 v16, 0x8000, v16
    v_xor_b32 v17, 0x8000, v17
    s_and_b32 s37, s37, 0xffff
    s_waitcnt vmcnt(6) lgkmcnt(0)
    s_barrier
    v_mfma_f32_16x16x32_bf16 v[52:55], v[148:151], v[104:107], v[52:55]
    s_cmp_lg_u32 s40, s38
    s_cbranch_scc1 L_g_nopoll0
    global_load_dword v8, v9, s[32:33] sc1
L_g_nopoll0:
    ds_read_b128 v[124:127], v5 offset:0
    ds_read_b128 v[128:131], v5 offset:2048
    v_mfma_f32_16x16x32_bf16 v[56:59], v[152:155], v[104:107], v[56:59]
    ds_read_b128 v[132:135], v6 offset:0
    ds_read_b128 v[136:139], v6 offset:2048
    v_mfma_f32_16x16x32_bf16 v[60:63], v[148:151], v[108:111], v[60:63]
    buffer_load_dwordx4 v192, s[8:11], s58 offen offset:0 lds
    ds_read_b64_tr_b16 v[92:93], v10 offset:0
    ds_read_b64_tr_b16 v[94:95], v10 offset:1024
    v_mfma_f32_16x16x32_bf16 v[64:67], v[152:155], v[108:111], v[64:67]
    ds_read_b64_tr_b16 v[96:97], v11 offset:0
    ds_read_b64_tr_b16 v[98:99], v11 offset:1024
    v_mfma_f32_16x16x32_bf16 v[68:71], v[148:151], v[112:115], v[68:71]
    ds_read_b64_tr_b16 v[100:101], v12 offset:0
    ds_read_b64_tr_b16 v[102:103], v12 offset:1024
    v_mfma_f32_16x16x32_bf16 v[72:75], v[152:155], v[112:115], v[72:75]
    ds_read_b64_tr_b16 v[104:105], v13 offset:0
    ds_read_b64_tr_b16 v[106:107], v13 offset:1024
    v_mfma_f32_16x16x32_bf16 v[76:79], v[148:151], v[116:119], v[76:79]
    buffer_load_dwordx4 v193, s[8:11], s58 offen offset:1024 lds
    ds_read_b64_tr_b16 v[108:109], v14 offset:0
    ds_read_b64_tr_b16 v[110:111], v14 offset:1024
    v_mfma_f32_16x16x32_bf16 v[80:83], v[152:155], v[116:119], v[80:83]
    ds_read_b64_tr_b16 v[112:113], v15 offset:0
    ds_read_b64_tr_b16 v[114:115], v15 offset:1024
    v_mfma_f32_16x16x32_bf16 v[84:87], v[148:151], v[120:123], v[84:87]
    ds_read_b64_tr_b16 v[116:117], v16 offset:0
    ds_read_b64_tr_b16 v[118:119], v16 offset:1024
    v_mfma_f32_16x16x32_bf16 v[88:91], v[152:155], v[120:123], v[88:91]
    s_add_u32 s40, s40, 1
    s_cmp_lt_u32 s40, 5
    s_cbranch_scc1 L_g_loop
L_g_epi:
    s_mov_b32 s29, 0xffff0000
    v_cmp_gt_u32 vcc, 8, v2
    v_mov_b32 v18, 0xff800000
    s_mov_b64 s[48:49], vcc
    v_cndmask_b32 v10, 0, 1.0, vcc
    v_cndmask_b32 v11, v18, 0, vcc
    s_nop 4
    s_mov_b32 s62, s42
    s_mov_b32 s63, s42
    s_mov_b32 s64, s43
    s_mov_b32 s65, s43
    s_mov_b32 s66, 1.0
    s_mov_b32 s67, 1.0
    s_waitcnt lgkmcnt(0)
    v_cvt_pk_bf16_f32 v22, v52, v53
    v_cvt_pk_bf16_f32 v23, v54, v55
    v_lshlrev_b32 v52, 16, v22
    v_and_b32 v53, s29, v22
    v_lshlrev_b32 v54, 16, v23
    v_and_b32 v55, s29, v23
    v_pk_mul_f32 v[18:19], v[52:53], s[62:63]
    v_pk_mul_f32 v[20:21], v[54:55], s[62:63]
    v_exp_f32 v18, v18
    v_exp_f32 v19, v19
    v_exp_f32 v20, v20
    v_exp_f32 v21, v21
    v_max_f32 v52, 0, v52
    v_max_f32 v53, 0, v53
    v_max_f32 v54, 0, v54
    v_max_f32 v55, 0, v55
    v_pk_add_f32 v[18:19], v[18:19], s[64:65] clamp
    v_pk_add_f32 v[20:21], v[20:21], s[64:65] clamp
    v_pk_add_f32 v[18:19], v[18:19], v[52:53]
    v_pk_add_f32 v[20:21], v[20:21], v[54:55]
    v_cvt_pk_bf16_f32 v92, v18, v19
    v_cvt_pk_bf16_f32 v93, v20, v21
    v_cvt_pk_bf16_f32 v22, v56, v57
    v_cvt_pk_bf16_f32 v23, v58, v59
    v_lshlrev_b32 v56, 16, v22
    v_and_b32 v57, s29, v22
    v_lshlrev_b32 v58, 16, v23
    v_and_b32 v59, s29, v23
    v_pk_mul_f32 v[18:19], v[56:57], s[62:63]
    v_pk_mul_f32 v[20:21], v[58:59], s[62:63]
    v_exp_f32 v18, v18
    v_exp_f32 v19, v19
    v_exp_f32 v20, v20
    v_exp_f32 v21, v21
    v_max_f32 v56, 0, v56
    v_max_f32 v57, 0, v57
    v_max_f32 v58, 0, v58
    v_max_f32 v59, 0, v59
    v_pk_add_f32 v[18:19], v[18:19], s[64:65] clamp
    v_pk_add_f32 v[20:21], v[20:21], s[64:65] clamp
    v_pk_add_f32 v[18:19], v[18:19], v[56:57]
    v_pk_add_f32 v[20:21], v[20:21], v[58:59]
    v_cvt_pk_bf16_f32 v94, v18, v19
    v_cvt_pk_bf16_f32 v95, v20, v21
    v_cvt_pk_bf16_f32 v22, v60, v61
    v_cvt_pk_bf16_f32 v23, v62, v63
    v_lshlrev_b32 v60, 16, v22
    v_and_b32 v61, s29, v22
    v_lshlrev_b32 v62, 16, v23
    v_and_b32 v63, s29, v23
    v_pk_mul_f32 v[18:19], v[60:61], s[62:63]
    v_pk_mul_f32 v[20:21], v[62:63], s[62:63]
    v_exp_f32 v18, v18
    v_exp_f32 v19, v19
    v_exp_f32 v20, v20
    v_exp_f32 v21, v21
    v_max_f32 v60, 0, v60
    v_max_f32 v61, 0, v61
    v_max_f32 v62, 0, v62
    v_max_f32 v63, 0, v63
    v_pk_add_f32 v[18:19], v[18:19], s[64:65] clamp
    v_pk_add_f32 v[20:21], v[20:21], s[64:65] clamp
    v_pk_add_f32 v[18:19], v[18:19], v[60:61]
    v_pk_add_f32 v[20:21], v[20:21], v[62:63]
    v_cvt_pk_bf16_f32 v96, v18, v19
    v_cvt_pk_bf16_f32 v97, v20, v21
    v_cvt_pk_bf16_f32 v22, v64, v65
    v_cvt_pk_bf16_f32 v23, v66, v67
    v_lshlrev_b32 v64, 16, v22
    v_and_b32 v65, s29, v22
    v_lshlrev_b32 v66, 16, v23
    v_and_b32 v67, s29, v23
    v_pk_mul_f32 v[18:19], v[64:65], s[62:63]
    v_pk_mul_f32 v[20:21], v[66:67], s[62:63]
    v_exp_f32 v18, v18
    v_exp_f32 v19, v19
    v_exp_f32 v20, v20
    v_exp_f32 v21, v21
    v_max_f32 v64, 0, v64
    v_max_f32 v65, 0, v65
    v_max_f32 v66, 0, v66
    v_max_f32 v67, 0, v67
    v_pk_add_f32 v[18:19], v[18:19], s[64:65] clamp
    v_pk_add_f32 v[20:21], v[20:21], s[64:65] clamp
    v_pk_add_f32 v[18:19], v[18:19], v[64:65]
    v_pk_add_f32 v[20:21], v[20:21], v[66:67]
    v_cvt_pk_bf16_f32 v98, v18, v19
    v_cvt_pk_bf16_f32 v99, v20, v21
    v_cvt_pk_bf16_f32 v22, v68, v69
    v_cvt_pk_bf16_f32 v23, v70, v71
    v_lshlrev_b32 v68, 16, v22
    v_and_b32 v69, s29, v22
    v_lshlrev_b32 v70, 16, v23
    v_and_b32 v71, s29, v23
    v_pk_mul_f32 v[18:19], v[68:69], s[62:63]
    v_pk_mul_f32 v[20:21], v[70:71], s[62:63]
    v_exp_f32 v18, v18
    v_exp_f32 v19, v19
    v_exp_f32 v20, v20
    v_exp_f32 v21, v21
    v_max_f32 v68, 0, v68
    v_max_f32 v69, 0, v69
    v_max_f32 v70, 0, v70
    v_max_f32 v71, 0, v71
    v_pk_add_f32 v[18:19], v[18:19], s[64:65] clamp
    v_pk_add_f32 v[20:21], v[20:21], s[64:65] clamp
    v_pk_add_f32 v[18:19], v[18:19], v[68:69]
    v_pk_add_f32 v[20:21], v[20:21], v[70:71]
    v_cvt_pk_bf16_f32 v100, v18, v19
    v_cvt_pk_bf16_f32 v101, v20, v21
    v_cndmask_b32 v100, v22, v100, s[48:49]
    v_cndmask_b32 v101, v23, v101, s[48:49]
    v_cvt_pk_bf16_f32 v22, v72, v73
    v_cvt_pk_bf16_f32 v23, v74, v75
    v_lshlrev_b32 v72, 16, v22
    v_and_b32 v73, s29, v22
    v_lshlrev_b32 v74, 16, v23
    v_and_b32 v75, s29, v23
    v_pk_mul_f32 v[18:19], v[72:73], s[62:63]
    v_pk_mul_f32 v[20:21], v[74:75], s[62:63]
    v_exp_f32 v18, v18
    v_exp_f32 v19, v19
    v_exp_f32 v20, v20
    v_exp_f32 v21, v21
    v_max_f32 v72, 0, v72
    v_max_f32 v73, 0, v73
    v_max_f32 v74, 0, v74
    v_max_f32 v75, 0, v75
    v_pk_add_f32 v[18:19], v[18:19], s[64:65] clamp
    v_pk_add_f32 v[20:21], v[20:21], s[64:65] clamp
    v_pk_add_f32 v[18:19], v[18:19], v[72:73]
    v_pk_add_f32 v[20:21], v[20:21], v[74:75]
    v_cvt_pk_bf16_f32 v102, v18, v19
    v_cvt_pk_bf16_f32 v103, v20, v21
    v_cndmask_b32 v102, v22, v102, s[48:49]
    v_cndmask_b32 v103, v23, v103, s[48:49]
    v_cvt_pk_bf16_f32 v104, v76, v77
    v_cvt_pk_bf16_f32 v105, v78, v79
    v_cvt_pk_bf16_f32 v106, v80, v81
    v_cvt_pk_bf16_f32 v107, v82, v83
    v_cvt_pk_bf16_f32 v108, v84, v85
    v_cvt_pk_bf16_f32 v109, v86, v87
    v_cvt_pk_bf16_f32 v110, v88, v89
    v_cvt_pk_bf16_f32 v111, v90, v91
    v_mov_b32 v18, 0x3f803f80
    v_cndmask_b32 v112, v100, v18, s[48:49]
    v_cndmask_b32 v113, v101, v18, s[48:49]
    v_cndmask_b32 v114, v102, v18, s[48:49]
    v_cndmask_b32 v115, v103, v18, s[48:49]
    s_nop 1
    s_waitcnt vmcnt(0)
    v_mfma_f32_16x16x32_bf16 v[124:127], v[92:95], v[104:107], 0
    v_mfma_f32_16x16x32_bf16 v[128:131], v[100:103], v[104:107], 0
    v_mfma_f32_16x16x32_bf16 v[132:135], v[92:95], v[112:115], 0
    v_mfma_f32_16x16x32_bf16 v[136:139], v[100:103], v[112:115], 0
    v_mfma_f32_16x16x32_bf16 v[140:143], v[96:99], v[108:111], 0
    v_mfma_f32_16x16x32_bf16 v[144:147], v[100:103], v[108:111], 0
    v_mfma_f32_16x16x32_bf16 v[148:151], v[96:99], v[112:115], 0
    v_cmp_eq_u32 s[46:47], 1, v3
    v_cmp_eq_u32 vcc, 1, v2
    v_cmp_le_u32 s[30:31], 12, v2
    s_nop 0
    s_or_b64 s[30:31], vcc, s[30:31]
    s_nop 7
    v_cndmask_b32 v128, v128, v144, s[46:47]
    v_cndmask_b32 v132, v132, v148, s[30:31]
    v_cndmask_b32 v129, v129, v145, s[46:47]
    v_cndmask_b32 v133, v133, v149, s[30:31]
    v_cndmask_b32 v130, v130, v146, s[46:47]
    v_cndmask_b32 v134, v134, v150, s[30:31]
    v_cndmask_b32 v131, v131, v147, s[46:47]
    v_cndmask_b32 v135, v135, v151, s[30:31]
    v_lshlrev_b32 v18, 4, v1
    v_add_u32 v18, s52, v18
    ds_write_b128 v18, v[124:127] offset:0
    ds_write_b128 v18, v[140:143] offset:1024
    ds_write_b128 v18, v[128:131] offset:2048
    ds_write_b128 v18, v[132:135] offset:3072
    ds_write_b128 v18, v[136:139] offset:4096
    v_lshlrev_b32 v4, 2, v0
    v_add_u32 v7, 65536, v4
    v_cvt_pk_bf16_f32 v22, v28, v29
    v_cvt_pk_bf16_f32 v23, v30, v31
    v_lshlrev_b32 v28, 16, v22
    v_and_b32 v29, s29, v22
    v_lshlrev_b32 v30, 16, v23
    v_and_b32 v31, s29, v23
    v_pk_mul_f32 v[18:19], v[28:29], s[62:63]
    v_pk_mul_f32 v[20:21], v[30:31], s[62:63]
    v_exp_f32 v18, v18
    v_exp_f32 v19, v19
    v_exp_f32 v20, v20
    v_exp_f32 v21, v21
    v_max_f32 v28, 0, v28
    v_max_f32 v29, 0, v29
    v_max_f32 v30, 0, v30
    v_max_f32 v31, 0, v31
    v_pk_add_f32 v[18:19], v[18:19], s[64:65] clamp
    v_pk_add_f32 v[20:21], v[20:21], s[64:65] clamp
    v_pk_add_f32 v[18:19], v[18:19], v[28:29]
    v_pk_add_f32 v[20:21], v[20:21], v[30:31]
    v_cvt_pk_bf16_f32 v92, v18, v19
    v_cvt_pk_bf16_f32 v93, v20, v21
    v_cvt_pk_bf16_f32 v22, v36, v37
    v_cvt_pk_bf16_f32 v23, v38, v39
    v_lshlrev_b32 v36, 16, v22
    v_and_b32 v37, s29, v22
    v_lshlrev_b32 v38, 16, v23
    v_and_b32 v39, s29, v23
    v_pk_mul_f32 v[18:19], v[36:37], s[62:63]
    v_pk_mul_f32 v[20:21], v[38:39], s[62:63]
    v_exp_f32 v18, v18
    v_exp_f32 v19, v19
    v_exp_f32 v20, v20
    v_exp_f32 v21, v21
    v_max_f32 v36, 0, v36
    v_max_f32 v37, 0, v37
    v_max_f32 v38, 0, v38
    v_max_f32 v39, 0, v39
    v_pk_add_f32 v[18:19], v[18:19], s[64:65] clamp
    v_pk_add_f32 v[20:21], v[20:21], s[64:65] clamp
    v_pk_add_f32 v[18:19], v[18:19], v[36:37]
    v_pk_add_f32 v[20:21], v[20:21], v[38:39]
    v_cvt_pk_bf16_f32 v94, v18, v19
    v_cvt_pk_bf16_f32 v95, v20, v21
    v_cvt_pk_bf16_f32 v22, v44, v45
    v_cvt_pk_bf16_f32 v23, v46, v47
    v_lshlrev_b32 v44, 16, v22
    v_and_b32 v45, s29, v22
    v_lshlrev_b32 v46, 16, v23
    v_and_b32 v47, s29, v23
    v_pk_mul_f32 v[18:19], v[44:45], s[62:63]
    v_pk_mul_f32 v[20:21], v[46:47], s[62:63]
    v_exp_f32 v18, v18
    v_exp_f32 v19, v19
    v_exp_f32 v20, v20
    v_exp_f32 v21, v21
    v_max_f32 v44, 0, v44
    v_max_f32 v45, 0, v45
    v_max_f32 v46, 0, v46
    v_max_f32 v47, 0, v47
    v_pk_add_f32 v[18:19], v[18:19], s[64:65] clamp
    v_pk_add_f32 v[20:21], v[20:21], s[64:65] clamp
    v_pk_add_f32 v[18:19], v[18:19], v[44:45]
    v_pk_add_f32 v[20:21], v[20:21], v[46:47]
    v_cvt_pk_bf16_f32 v96, v18, v19
    v_cvt_pk_bf16_f32 v97, v20, v21
    s_cmp_lg_u32 s26, 0
    s_cbranch_scc1 L_g_polled
L_g_poll:
    v_readfirstlane_b32 s28, v8
    s_cmp_lg_u32 s28, 0
    s_cbranch_scc1 L_g_polled
    s_sleep 8
    global_load_dword v8, v9, s[32:33] sc1
    s_waitcnt vmcnt(0)
    s_branch L_g_poll
L_g_polled:
    s_waitcnt lgkmcnt(0)
    s_barrier
    s_cmp_ge_u32 s26, 4
    s_cbranch_scc1 L_g_at2
    ds_read2st64_b32 v[124:125], v7 offset0:0 offset1:32
    ds_read2st64_b32 v[126:127], v7 offset0:64 offset1:96
    ds_read2st64_b32 v[52:53], v7 offset0:128 offset1:160
    ds_read2st64_b32 v[54:55], v7 offset0:192 offset1:224
    ds_read2st64_b32 v[128:129], v7 offset0:4 offset1:36
    ds_read2st64_b32 v[130:131], v7 offset0:68 offset1:100
    ds_read2st64_b32 v[56:57], v7 offset0:132 offset1:164
    ds_read2st64_b32 v[58:59], v7 offset0:196 offset1:228
    ds_read2st64_b32 v[132:133], v7 offset0:8 offset1:40
    ds_read2st64_b32 v[134:135], v7 offset0:72 offset1:104
    ds_read2st64_b32 v[60:61], v7 offset0:136 offset1:168
    ds_read2st64_b32 v[62:63], v7 offset0:200 offset1:232
    ds_read2st64_b32 v[136:137], v7 offset0:12 offset1:44
    ds_read2st64_b32 v[138:139], v7 offset0:76 offset1:108
    ds_read2st64_b32 v[64:65], v7 offset0:140 offset1:172
    ds_read2st64_b32 v[66:67], v7 offset0:204 offset1:236
    ds_read2st64_b32 v[140:141], v7 offset0:16 offset1:48
    ds_read2st64_b32 v[142:143], v7 offset0:80 offset1:112
    ds_read2st64_b32 v[68:69], v7 offset0:144 offset1:176
    ds_read2st64_b32 v[70:71], v7 offset0:208 offset1:240
    s_waitcnt lgkmcnt(0)
    v_pk_add_f32 v[124:125], v[124:125], v[52:53]
    v_pk_add_f32 v[126:127], v[126:127], v[54:55]
    v_pk_add_f32 v[128:129], v[128:129], v[56:57]
    v_pk_add_f32 v[130:131], v[130:131], v[58:59]
    v_pk_add_f32 v[132:133], v[132:133], v[60:61]
    v_pk_add_f32 v[134:135], v[134:135], v[62:63]
    v_pk_add_f32 v[136:137], v[136:137], v[64:65]
    v_pk_add_f32 v[138:139], v[138:139], v[66:67]
    v_pk_add_f32 v[140:141], v[140:141], v[68:69]
    v_pk_add_f32 v[142:143], v[142:143], v[70:71]
    v_pk_add_f32 v[124:125], v[124:125], v[126:127]
    v_pk_add_f32 v[128:129], v[128:129], v[130:131]
    v_pk_add_f32 v[132:133], v[132:133], v[134:135]
    v_pk_add_f32 v[136:137], v[136:137], v[138:139]
    v_pk_add_f32 v[140:141], v[140:141], v[142:143]
    v_add_f32 v124, v124, v125
    v_add_f32 v128, v128, v129
    v_add_f32 v132, v132, v133
    v_add_f32 v136, v136, v137
    v_add_f32 v140, v140, v141
    s_mul_i32 s28, s25, 5120
    buffer_atomic_add_f32 v124, v4, s[12:15], s28 offen
    buffer_atomic_add_f32 v128, v4, s[12:15], s28 offen offset:1024
    s_mov_b32 s46, 0xff
    s_mov_b32 s47, -1
    s_mov_b64 exec, s[46:47]
    buffer_atomic_add_f32 v136, v4, s[12:15], s28 offen offset:3072
    s_cmp_ge_u32 s26, 2
    s_cbranch_scc1 L_g_at2
    s_add_u32 s30, s28, 4096
    buffer_atomic_add_f32 v140, v4, s[12:15], s30 offen
    s_mov_b64 exec, -1
    buffer_atomic_add_f32 v132, v4, s[12:15], s28 offen offset:2048
L_g_at2:
    s_mov_b64 exec, -1
L_g_nowof2:
    s_mov_b32 s29, 0xffff0000
    v_cvt_pk_bf16_f32 v22, v32, v33
    v_cvt_pk_bf16_f32 v23, v34, v35
    v_lshlrev_b32 v32, 16, v22
    v_and_b32 v33, s29, v22
    v_lshlrev_b32 v34, 16, v23
    v_and_b32 v35, s29, v23
    v_pk_mul_f32 v[18:19], v[32:33], s[62:63]
    v_pk_mul_f32 v[20:21], v[34:35], s[62:63]
    v_exp_f32 v18, v18
    v_exp_f32 v19, v19
    v_exp_f32 v20, v20
    v_exp_f32 v21, v21
    v_max_f32 v32, 0, v32
    v_max_f32 v33, 0, v33
    v_max_f32 v34, 0, v34
    v_max_f32 v35, 0, v35
    v_pk_add_f32 v[18:19], v[18:19], s[64:65] clamp
    v_pk_add_f32 v[20:21], v[20:21], s[64:65] clamp
    v_pk_add_f32 v[18:19], v[18:19], v[32:33]
    v_pk_add_f32 v[20:21], v[20:21], v[34:35]
    v_cvt_pk_bf16_f32 v100, v18, v19
    v_cvt_pk_bf16_f32 v101, v20, v21
    v_cvt_pk_bf16_f32 v22, v40, v41
    v_cvt_pk_bf16_f32 v23, v42, v43
    v_lshlrev_b32 v40, 16, v22
    v_and_b32 v41, s29, v22
    v_lshlrev_b32 v42, 16, v23
    v_and_b32 v43, s29, v23
    v_pk_mul_f32 v[18:19], v[40:41], s[62:63]
    v_pk_mul_f32 v[20:21], v[42:43], s[62:63]
    v_exp_f32 v18, v18
    v_exp_f32 v19, v19
    v_exp_f32 v20, v20
    v_exp_f32 v21, v21
    v_max_f32 v40, 0, v40
    v_max_f32 v41, 0, v41
    v_max_f32 v42, 0, v42
    v_max_f32 v43, 0, v43
    v_pk_add_f32 v[18:19], v[18:19], s[64:65] clamp
    v_pk_add_f32 v[20:21], v[20:21], s[64:65] clamp
    v_pk_add_f32 v[18:19], v[18:19], v[40:41]
    v_pk_add_f32 v[20:21], v[20:21], v[42:43]
    v_cvt_pk_bf16_f32 v102, v18, v19
    v_cvt_pk_bf16_f32 v103, v20, v21
    v_cvt_pk_bf16_f32 v22, v48, v49
    v_cvt_pk_bf16_f32 v23, v50, v51
    v_lshlrev_b32 v48, 16, v22
    v_and_b32 v49, s29, v22
    v_lshlrev_b32 v50, 16, v23
    v_and_b32 v51, s29, v23
    v_pk_mul_f32 v[18:19], v[48:49], s[62:63]
    v_pk_mul_f32 v[20:21], v[50:51], s[62:63]
    v_exp_f32 v18, v18
    v_exp_f32 v19, v19
    v_exp_f32 v20, v20
    v_exp_f32 v21, v21
    v_max_f32 v48, 0, v48
    v_max_f32 v49, 0, v49
    v_max_f32 v50, 0, v50
    v_max_f32 v51, 0, v51
    v_pk_add_f32 v[18:19], v[18:19], s[64:65] clamp
    v_pk_add_f32 v[20:21], v[20:21], s[64:65] clamp
    v_pk_add_f32 v[18:19], v[18:19], v[48:49]
    v_pk_add_f32 v[20:21], v[20:21], v[50:51]
    v_cvt_pk_bf16_f32 v104, v18, v19
    v_cvt_pk_bf16_f32 v105, v20, v21
    s_lshl_b32 s28, s24, 4
    s_lshl_b32 s30, s26, 1
    s_add_u32 s28, s28, s30
    s_lshl_b32 s28, s28, 3
    s_lshr_b32 s30, s25, 1
    s_add_u32 s28, s28, s30
    s_mul_i32 s28, s28, 3072
    s_add_u32 s28, s28, 2097152
    s_add_u32 s30, s28, 24576
    v_lshlrev_b32 v18, 4, v1
    s_and_b32 s31, s25, 1
    s_cmp_eq_u32 s31, 1
    s_cbranch_scc1 L_g_pq1
    buffer_store_dwordx4 v[92:95], v18, s[12:15], s28 offen sc1
    buffer_store_dwordx2 v[96:97], v18, s[12:15], s28 offen offset:1024 sc1
    buffer_store_dwordx4 v[100:103], v18, s[12:15], s30 offen sc1
    buffer_store_dwordx2 v[104:105], v18, s[12:15], s30 offen offset:1024 sc1
    s_endpgm
L_g_pq1:
    buffer_store_dwordx2 v[92:93], v18, s[12:15], s28 offen offset:1032 sc1
    buffer_store_dwordx4 v[94:97], v18, s[12:15], s28 offen offset:2048 sc1
    buffer_store_dwordx2 v[100:101], v18, s[12:15], s30 offen offset:1032 sc1
    buffer_store_dwordx4 v[102:105], v18, s[12:15], s30 offen offset:2048 sc1
    s_endpgm
L_conv:
    s_load_dwordx16 s[4:19], s[0:1], 0
    s_load_dwordx2 s[20:21], s[0:1], 64
    s_load_dwordx2 s[46:47], s[0:1], 120
    s_load_dwordx2 s[58:59], s[0:1], 96
    s_load_dwordx2 s[64:65], s[0:1], 88
    s_sub_u32 s30, s2, 128
    s_and_b32 s22, s30, 7
    s_lshr_b32 s23, s30, 3
    s_lshl_b32 s30, s22, 4
    s_add_u32 s30, s30, s23
    s_mul_i32 s24, s30, 5
    v_lshrrev_b32 v6, 6, v0
    v_and_b32 v1, 63, v0
    v_readfirstlane_b32 s25, v6
    v_and_b32 v2, 15, v0
    v_lshrrev_b32 v3, 4, v1
    v_lshlrev_b32 v4, 4, v1
    s_and_b32 s27, s25, 3
    s_lshr_b32 s28, s25, 2
    s_sub_u32 s26, 3, s28
    s_cmp_eq_u32 s28, 0
    s_cbranch_scc1 L_c_noprio
    s_setprio 1
L_c_noprio:
    s_and_b32 s30, s24, 0xfffe
    s_lshl_b32 s30, s30, 1
    s_add_u32 s31, s30, 8
    s_waitcnt lgkmcnt(0)
    s_load_dwordx2 s[42:43], s[18:19], s30
    s_load_dword s60, s[18:19], s31
    s_load_dwordx2 s[44:45], s[20:21], s30
    s_load_dword s61, s[20:21], s31
    v_and_b32 v6, 31, v1
    s_add_u32 s31, s24, s28
    s_lshl_b32 s31, s31, 8
    s_lshl_b32 s34, s27, 6
    s_add_u32 s31, s31, s34
    v_lshl_add_u32 v7, v6, 1, s31
    global_load_ushort v52, v7, s[6:7] offset:0
    global_load_ushort v53, v7, s[8:9] offset:0
    global_load_ushort v54, v7, s[10:11] offset:0
    global_load_ushort v55, v7, s[12:13] offset:0
    global_load_ushort v56, v7, s[14:15] offset:0
    global_load_ushort v57, v7, s[16:17] offset:0
    global_load_ushort v58, v7, s[6:7] offset:512
    global_load_ushort v59, v7, s[8:9] offset:512
    global_load_ushort v60, v7, s[10:11] offset:512
    global_load_ushort v61, v7, s[12:13] offset:512
    global_load_ushort v62, v7, s[14:15] offset:512
    global_load_ushort v63, v7, s[16:17] offset:512
    s_cmp_lt_u32 s26, 3
    s_cbranch_scc1 L_c_nop2
    global_load_ushort v64, v7, s[6:7] offset:1024
    global_load_ushort v65, v7, s[8:9] offset:1024
    global_load_ushort v66, v7, s[10:11] offset:1024
    global_load_ushort v67, v7, s[12:13] offset:1024
    global_load_ushort v68, v7, s[14:15] offset:1024
    global_load_ushort v69, v7, s[16:17] offset:1024
L_c_nop2:
    s_mov_b32 s52, s4
    s_and_b32 s53, s5, 0xffff
    s_mov_b32 s54, 2621440
    s_mov_b32 s55, 0x00020000
    s_movk_i32 s31, 2560
    v_and_b32 v8, 255, v0
    v_mul_u32_u24 v8, s31, v8
    s_mov_b32 s31, s30
    v_mov_b32 v32, v8
    s_mov_b32 s62, s30
    s_mov_b32 s48, s46
    s_and_b32 s49, s47, 0xffff
    s_mov_b32 s50, 13631488
    s_mov_b32 s51, 0x00020000
    s_mul_i32 s38, s25, 10496
    v_lshrrev_b32 v7, 5, v1
    v_lshrrev_b32 v8, 2, v6
    v_and_b32 v9, 3, v6
    v_lshlrev_b32 v9, 2, v9
    v_lshl_add_u32 v9, v7, 7, v9
    v_add_u32 v9, s38, v9
    v_xor_b32 v10, 0, v8
    v_lshl_add_u32 v79, v10, 4, v9
    v_xor_b32 v87, 0x80, v79
    v_xor_b32 v10, 1, v8
    v_lshl_add_u32 v80, v10, 4, v9
    v_xor_b32 v88, 0x80, v80
    v_xor_b32 v10, 2, v8
    v_lshl_add_u32 v81, v10, 4, v9
    v_xor_b32 v89, 0x80, v81
    v_xor_b32 v10, 3, v8
    v_lshl_add_u32 v82, v10, 4, v9
    v_xor_b32 v90, 0x80, v82
    v_xor_b32 v10, 4, v8
    v_lshl_add_u32 v83, v10, 4, v9
    v_xor_b32 v91, 0x80, v83
    v_xor_b32 v10, 5, v8
    v_lshl_add_u32 v84, v10, 4, v9
    v_xor_b32 v92, 0x80, v84
    v_xor_b32 v10, 6, v8
    v_lshl_add_u32 v85, v10, 4, v9
    v_xor_b32 v93, 0x80, v85
    v_xor_b32 v10, 7, v8
    v_lshl_add_u32 v86, v10, 4, v9
    v_xor_b32 v94, 0x80, v86
    v_cmp_lt_u32 s[36:37], 31, v1
    v_mov_b32 v10, v2
    v_and_b32 v11, 15, v10
    v_xor_b32 v11, v11, v3
    v_lshlrev_b32 v10, 8, v10
    v_lshl_add_u32 v10, v11, 4, v10
    v_add_u32 v10, s38, v10
    v_mov_b32 v103, v10
    v_xor_b32 v104, 64, v10
    v_xor_b32 v95, 0x80, v10
    v_xor_b32 v96, 0xc0, v10
    v_lshlrev_b32 v10, 1, v2
    v_mov_b32 v11, 0
    v_cmp_le_u32 vcc, 16, v10
    s_nop 1
    v_addc_co_u32 v11, vcc, 0, v11, vcc
    v_lshrrev_b32 v10, v11, v10
    v_lshl_add_u32 v10, v11, 3, v10
    v_and_b32 v11, 15, v10
    v_xor_b32 v11, v11, v3
    v_lshlrev_b32 v10, 8, v10
    v_lshl_add_u32 v10, v11, 4, v10
    v_add_u32 v10, s38, v10
    v_xor_b32 v97, 0x80, v10
    v_xor_b32 v98, 0xc0, v10
    v_lshlrev_b32 v10, 2, v2
    v_mov_b32 v11, 0
    v_cmp_le_u32 vcc, 16, v10
    s_nop 1
    v_addc_co_u32 v11, vcc, 0, v11, vcc
    v_cmp_le_u32 vcc, 32, v10
    s_nop 1
    v_addc_co_u32 v11, vcc, 0, v11, vcc
    v_lshrrev_b32 v10, v11, v10
    v_lshl_add_u32 v10, v11, 3, v10
    v_and_b32 v11, 15, v10
    v_xor_b32 v11, v11, v3
    v_lshlrev_b32 v10, 8, v10
    v_lshl_add_u32 v10, v11, 4, v10
    v_add_u32 v10, s38, v10
    v_xor_b32 v99, 0x80, v10
    v_xor_b32 v100, 0xc0, v10
    v_lshlrev_b32 v10, 3, v2
    v_mov_b32 v11, 0
    v_cmp_le_u32 vcc, 16, v10
    s_nop 1
    v_addc_co_u32 v11, vcc, 0, v11, vcc
    v_cmp_le_u32 vcc, 32, v10
    s_nop 1
    v_addc_co_u32 v11, vcc, 0, v11, vcc
    v_cmp_le_u32 vcc, 64, v10
    s_nop 1
    v_addc_co_u32 v11, vcc, 0, v11, vcc
    v_lshrrev_b32 v10, v11, v10
    v_lshl_add_u32 v10, v11, 3, v10
    v_and_b32 v11, 15, v10
    v_xor_b32 v11, v11, v3
    v_lshlrev_b32 v10, 8, v10
    v_lshl_add_u32 v10, v11, 4, v10
    v_add_u32 v10, s38, v10
    v_xor_b32 v101, 0x80, v10
    v_xor_b32 v102, 0xc0, v10
    v_mov_b32 v6, 0x3fb8aa3b
    v_mov_b32 v7, 0x41b8aa3b
    v_cndmask_b32 v74, v7, v6, s[36:37]
    v_mov_b32 v7, 0x4022f983
    v_mov_b32 v8, 0xbe22f983
    v_cndmask_b32 v75, v7, v8, s[36:37]
    s_mov_b32 s39, 0
    s_mov_b32 s40, 0xffff0000
    s_mul_i32 s56, s25, 3072
    s_add_u32 s56, s56, 90112
    s_waitcnt lgkmcnt(0)
    s_and_b32 s30, s24, 1
    s_add_u32 s31, s30, s28
    s_lshl_b32 s31, s31, 4
    s_mov_b32 s34, s43
    s_mov_b32 s35, s60
    s_lshr_b64 s[42:43], s[42:43], s31
    s_lshr_b64 s[34:35], s[34:35], s31
    s_mov_b32 s43, s34
    s_mov_b32 s60, s35
    s_lshl_b32 s31, s30, 4
    s_mov_b32 s34, s45
    s_mov_b32 s35, s61
    s_lshr_b64 s[44:45], s[44:45], s31
    s_lshr_b64 s[34:35], s[34:35], s31
    s_mov_b32 s45, s34
    s_mov_b32 s61, s35
    s_waitcnt vmcnt(0)
    s_and_b32 s65, s65, 0xffff
    s_mov_b32 s66, 819200
    s_mov_b32 s67, 0x00020000
    s_sub_u32 s68, s2, 128
    s_cmp_ge_u32 s68, 80
    s_cbranch_scc1 L_c_nowt
    s_and_b32 s31, s68, 3
    s_mul_i32 s31, s31, 160
    s_lshl_b32 s32, s25, 4
    s_add_u32 s31, s31, s32
    s_mul_i32 s31, s31, 1280
    s_lshr_b32 s32, s68, 2
    s_lshl_b32 s32, s32, 6
    s_add_u32 s31, s31, s32
    v_lshrrev_b32 v8, 2, v1
    v_mul_u32_u24 v8, 1280, v8
    v_and_b32 v9, 3, v1
    v_lshl_add_u32 v8, v9, 4, v8
    s_lshl_b32 s32, s25, 10
    s_add_u32 m0, s32, 151552
    s_nop 0
    buffer_load_dwordx4 v8, s[64:67], s31 offen lds
    s_cmp_ge_u32 s25, 2
    s_cbranch_scc1 L_c_nowt
    s_add_u32 m0, s32, 159744
    s_add_u32 s31, s31, 163840
    buffer_load_dwordx4 v8, s[64:67], s31 offen lds
L_c_nowt:
    s_cmp_eq_u32 s28, 0
    s_cbranch_scc1 L_c_nogl
    s_sub_u32 s30, s2, 128
    s_lshl_b32 s30, s30, 4
    s_lshl_b32 s31, s27, 2
    s_add_u32 s30, s30, s31
    v_lshrrev_b32 v210, 5, v1
    v_add_u32 v210, s30, v210
    v_and_b32 v7, 31, v1
    v_lshlrev_b32 v161, 4, v7
    v_lshlrev_b32 v162, 3, v7
    s_movk_i32 s31, 1280
    v_mad_u32_u24 v163, v210, s31, v161
    v_mad_u32_u24 v164, v210, s31, v162
    global_load_dwordx4 v[224:227], v161, s[58:59]
    global_load_dwordx4 v[228:231], v161, s[58:59] offset:512
    global_load_dwordx2 v[232:233], v162, s[58:59] offset:1024
    buffer_load_dwordx4 v[200:203], v163, s[52:55], 0 offen offset:0
    buffer_load_dwordx4 v[204:207], v163, s[52:55], 0 offen offset:512
    buffer_load_dwordx2 v[208:209], v164, s[52:55], 0 offen offset:1024
    buffer_load_dwordx4 v[212:215], v163, s[52:55], 0 offen offset:2560
    buffer_load_dwordx4 v[216:219], v163, s[52:55], 0 offen offset:3072
    buffer_load_dwordx2 v[220:221], v164, s[52:55], 0 offen offset:3584
L_c_nogl:
L_c_pass:
    s_lshl_b32 s30, s42, 16
    s_mov_b32 s42, s43
    s_mov_b32 s43, s60
    v_mov_b32 v6, 0x3fb8aa3b
    v_mul_f32 v76, s30, v6
    v_exp_f32 v76, v76
    v_lshlrev_b32 v6, 16, v52
    v_lshlrev_b32 v7, 16, v53
    v_lshlrev_b32 v8, 16, v54
    v_lshlrev_b32 v9, 16, v55
    v_lshlrev_b32 v10, 16, v56
    v_lshlrev_b32 v11, 16, v57
    v_cvt_pk_bf16_f32 v76, v76, v76
    v_mov_b32 v52, v58
    v_mov_b32 v53, v59
    v_mov_b32 v54, v60
    v_mov_b32 v55, v61
    v_mov_b32 v56, v62
    v_mov_b32 v57, v63
    v_lshlrev_b32 v76, 16, v76
    v_mov_b32 v58, v64
    v_mov_b32 v59, v65
    v_mov_b32 v60, v66
    v_mov_b32 v61, v67
    v_mov_b32 v62, v68
    v_mov_b32 v63, v69
    v_mul_f32 v77, v76, v74
    v_mul_f32 v78, v76, v75
    v_mul_f32 v8, v8, v76
    v_mul_f32 v9, v9, v76
    v_mul_f32 v70, v6, v77
    v_mul_f32 v71, v7, v78
    v_pk_mul_f32 v[124:125], v[10:11], v[8:9] op_sel:[0,0] op_sel_hi:[1,0]
    v_mul_f32 v72, 0x41800000, v70
    v_mul_f32 v73, 0x41800000, v71
    v_pk_fma_f32 v[124:125], v[10:11], v[8:9], v[124:125] op_sel:[1,1,0] op_sel_hi:[0,1,1] neg_lo:[1,0,0]
    v_fract_f32 v71, v71
    v_fract_f32 v73, v73
    v_exp_f32 v70, v70
    v_exp_f32 v72, v72
    v_cos_f32 v106, v71
    v_sin_f32 v107, v71
    v_cos_f32 v114, v73
    v_sin_f32 v115, v73
    v_cndmask_b32 v124, v124, 1.0, s[36:37]
    v_cndmask_b32 v125, v125, 0, s[36:37]
    v_mul_f32 v106, v106, v70
    v_mul_f32 v107, v107, v70
    v_mul_f32 v114, v114, v72
    v_mul_f32 v115, v115, v72
    s_cmp_eq_u32 s28, 0
    s_cbranch_scc1 L_c_ul0b
    s_cmp_lg_u32 s39, 0
    s_cbranch_scc1 L_c_ul0a
    buffer_load_dwordx3 v[16:18], v32, s[52:55], s62 offen
    buffer_load_dwordx3 v[20:22], v32, s[52:55], s62 offen offset:1280
    s_branch L_c_ul0b
L_c_ul0a:
    buffer_load_dwordx3 v[236:238], v32, s[52:55], s62 offen
    buffer_load_dwordx3 v[240:242], v32, s[52:55], s62 offen offset:1280
L_c_ul0b:
    s_add_u32 s62, s62, 655360
    v_pk_mul_f32 v[108:109], v[106:107], v[106:107] op_sel:[0,0] op_sel_hi:[1,0]
    v_pk_mul_f32 v[116:117], v[114:115], v[114:115] op_sel:[0,0] op_sel_hi:[1,0]
    v_pk_mul_f32 v[126:127], v[124:125], v[106:107] op_sel:[0,0] op_sel_hi:[1,0]
    v_pk_mul_f32 v[148:149], v[124:125], v[114:115] op_sel:[0,0] op_sel_hi:[1,0]
    v_pk_fma_f32 v[108:109], v[106:107], v[106:107], v[108:109] op_sel:[1,1,0] op_sel_hi:[0,1,1] neg_lo:[1,0,0]
    v_pk_fma_f32 v[116:117], v[114:115], v[114:115], v[116:117] op_sel:[1,1,0] op_sel_hi:[0,1,1] neg_lo:[1,0,0]
    v_pk_fma_f32 v[126:127], v[124:125], v[106:107], v[126:127] op_sel:[1,1,0] op_sel_hi:[0,1,1] neg_lo:[1,0,0]
    v_pk_fma_f32 v[148:149], v[124:125], v[114:115], v[148:149] op_sel:[1,1,0] op_sel_hi:[0,1,1] neg_lo:[1,0,0]
    v_pk_mul_f32 v[110:111], v[108:109], v[108:109] op_sel:[0,0] op_sel_hi:[1,0]
    v_pk_mul_f32 v[118:119], v[116:117], v[116:117] op_sel:[0,0] op_sel_hi:[1,0]
    v_pk_mul_f32 v[128:129], v[124:125], v[108:109] op_sel:[0,0] op_sel_hi:[1,0]
    v_pk_mul_f32 v[130:131], v[126:127], v[108:109] op_sel:[0,0] op_sel_hi:[1,0]
    v_pk_mul_f32 v[156:157], v[124:125], v[116:117] op_sel:[0,0] op_sel_hi:[1,0]
    v_pk_fma_f32 v[110:111], v[108:109], v[108:109], v[110:111] op_sel:[1,1,0] op_sel_hi:[0,1,1] neg_lo:[1,0,0]
    v_pk_fma_f32 v[118:119], v[116:117], v[116:117], v[118:119] op_sel:[1,1,0] op_sel_hi:[0,1,1] neg_lo:[1,0,0]
    v_pk_fma_f32 v[128:129], v[124:125], v[108:109], v[128:129] op_sel:[1,1,0] op_sel_hi:[0,1,1] neg_lo:[1,0,0]
    v_pk_fma_f32 v[130:131], v[126:127], v[108:109], v[130:131] op_sel:[1,1,0] op_sel_hi:[0,1,1] neg_lo:[1,0,0]
    v_pk_fma_f32 v[156:157], v[124:125], v[116:117], v[156:157] op_sel:[1,1,0] op_sel_hi:[0,1,1] neg_lo:[1,0,0]
    v_cvt_pk_bf16_f32 v180, v124, v125
    v_cvt_pk_bf16_f32 v181, v126, v127
    v_cvt_pk_bf16_f32 v196, v148, v149
    ds_write2st64_b32 v79, v180, v196 offset0:0 offset1:16
    v_pk_mul_f32 v[112:113], v[110:111], v[110:111] op_sel:[0,0] op_sel_hi:[1,0]
    v_pk_mul_f32 v[120:121], v[118:119], v[118:119] op_sel:[0,0] op_sel_hi:[1,0]
    v_pk_mul_f32 v[132:133], v[124:125], v[110:111] op_sel:[0,0] op_sel_hi:[1,0]
    v_pk_mul_f32 v[134:135], v[126:127], v[110:111] op_sel:[0,0] op_sel_hi:[1,0]
    v_pk_mul_f32 v[136:137], v[128:129], v[110:111] op_sel:[0,0] op_sel_hi:[1,0]
    v_pk_mul_f32 v[138:139], v[130:131], v[110:111] op_sel:[0,0] op_sel_hi:[1,0]
    v_pk_mul_f32 v[164:165], v[124:125], v[118:119] op_sel:[0,0] op_sel_hi:[1,0]
    v_pk_mul_f32 v[166:167], v[128:129], v[114:115] op_sel:[0,0] op_sel_hi:[1,0]
    v_pk_fma_f32 v[112:113], v[110:111], v[110:111], v[112:113] op_sel:[1,1,0] op_sel_hi:[0,1,1] neg_lo:[1,0,0]
    v_pk_fma_f32 v[120:121], v[118:119], v[118:119], v[120:121] op_sel:[1,1,0] op_sel_hi:[0,1,1] neg_lo:[1,0,0]
    v_pk_fma_f32 v[132:133], v[124:125], v[110:111], v[132:133] op_sel:[1,1,0] op_sel_hi:[0,1,1] neg_lo:[1,0,0]
    v_pk_fma_f32 v[134:135], v[126:127], v[110:111], v[134:135] op_sel:[1,1,0] op_sel_hi:[0,1,1] neg_lo:[1,0,0]
    v_pk_fma_f32 v[136:137], v[128:129], v[110:111], v[136:137] op_sel:[1,1,0] op_sel_hi:[0,1,1] neg_lo:[1,0,0]
    v_pk_fma_f32 v[138:139], v[130:131], v[110:111], v[138:139] op_sel:[1,1,0] op_sel_hi:[0,1,1] neg_lo:[1,0,0]
    v_pk_fma_f32 v[164:165], v[124:125], v[118:119], v[164:165] op_sel:[1,1,0] op_sel_hi:[0,1,1] neg_lo:[1,0,0]
    v_pk_fma_f32 v[166:167], v[128:129], v[114:115], v[166:167] op_sel:[1,1,0] op_sel_hi:[0,1,1] neg_lo:[1,0,0]
    v_cvt_pk_bf16_f32 v182, v128, v129
    v_cvt_pk_bf16_f32 v183, v130, v131
    v_cvt_pk_bf16_f32 v188, v156, v157
    v_pk_mul_f32 v[140:141], v[124:125], v[112:113] op_sel:[0,0] op_sel_hi:[1,0]
    v_pk_mul_f32 v[168:169], v[126:127], v[112:113] op_sel:[0,0] op_sel_hi:[1,0]
    v_pk_mul_f32 v[142:143], v[128:129], v[112:113] op_sel:[0,0] op_sel_hi:[1,0]
    v_pk_mul_f32 v[170:171], v[130:131], v[112:113] op_sel:[0,0] op_sel_hi:[1,0]
    v_pk_fma_f32 v[140:141], v[124:125], v[112:113], v[140:141] op_sel:[1,1,0] op_sel_hi:[0,1,1] neg_lo:[1,0,0]
    v_pk_fma_f32 v[168:169], v[126:127], v[112:113], v[168:169] op_sel:[1,1,0] op_sel_hi:[0,1,1] neg_lo:[1,0,0]
    v_pk_fma_f32 v[142:143], v[128:129], v[112:113], v[142:143] op_sel:[1,1,0] op_sel_hi:[0,1,1] neg_lo:[1,0,0]
    v_pk_fma_f32 v[170:171], v[130:131], v[112:113], v[170:171] op_sel:[1,1,0] op_sel_hi:[0,1,1] neg_lo:[1,0,0]
    v_cvt_pk_bf16_f32 v184, v132, v133
    v_cvt_pk_bf16_f32 v185, v134, v135
    v_cvt_pk_bf16_f32 v186, v136, v137
    v_cvt_pk_bf16_f32 v187, v138, v139
    v_pk_mul_f32 v[144:145], v[132:133], v[112:113] op_sel:[0,0] op_sel_hi:[1,0]
    v_pk_mul_f32 v[172:173], v[134:135], v[112:113] op_sel:[0,0] op_sel_hi:[1,0]
    v_pk_mul_f32 v[146:147], v[136:137], v[112:113] op_sel:[0,0] op_sel_hi:[1,0]
    v_pk_mul_f32 v[174:175], v[138:139], v[112:113] op_sel:[0,0] op_sel_hi:[1,0]
    v_pk_fma_f32 v[144:145], v[132:133], v[112:113], v[144:145] op_sel:[1,1,0] op_sel_hi:[0,1,1] neg_lo:[1,0,0]
    v_pk_fma_f32 v[172:173], v[134:135], v[112:113], v[172:173] op_sel:[1,1,0] op_sel_hi:[0,1,1] neg_lo:[1,0,0]
    v_pk_fma_f32 v[146:147], v[136:137], v[112:113], v[146:147] op_sel:[1,1,0] op_sel_hi:[0,1,1] neg_lo:[1,0,0]
    v_pk_fma_f32 v[174:175], v[138:139], v[112:113], v[174:175] op_sel:[1,1,0] op_sel_hi:[0,1,1] neg_lo:[1,0,0]
    v_cvt_pk_bf16_f32 v180, v164, v165
    v_cvt_pk_bf16_f32 v197, v166, v167
    v_cvt_pk_bf16_f32 v198, v140, v141
    v_cvt_pk_bf16_f32 v189, v168, v169
    ds_write2st64_b32 v80, v181, v197 offset0:1 offset1:17
    ds_write2st64_b32 v87, v188, v198 offset0:24 offset1:8
    v_pk_mul_f32 v[150:151], v[132:133], v[114:115] op_sel:[0,0] op_sel_hi:[1,0]
    v_pk_mul_f32 v[176:177], v[136:137], v[114:115] op_sel:[0,0] op_sel_hi:[1,0]
    v_pk_mul_f32 v[178:179], v[132:133], v[116:117] op_sel:[0,0] op_sel_hi:[1,0]
    v_pk_mul_f32 v[164:165], v[124:125], v[120:121] op_sel:[0,0] op_sel_hi:[1,0]
    v_pk_fma_f32 v[150:151], v[132:133], v[114:115], v[150:151] op_sel:[1,1,0] op_sel_hi:[0,1,1] neg_lo:[1,0,0]
    v_pk_fma_f32 v[176:177], v[136:137], v[114:115], v[176:177] op_sel:[1,1,0] op_sel_hi:[0,1,1] neg_lo:[1,0,0]
    v_pk_fma_f32 v[178:179], v[132:133], v[116:117], v[178:179] op_sel:[1,1,0] op_sel_hi:[0,1,1] neg_lo:[1,0,0]
    v_pk_fma_f32 v[164:165], v[124:125], v[120:121], v[164:165] op_sel:[1,1,0] op_sel_hi:[0,1,1] neg_lo:[1,0,0]
    v_cvt_pk_bf16_f32 v190, v142, v143
    v_cvt_pk_bf16_f32 v191, v170, v171
    v_cvt_pk_bf16_f32 v192, v144, v145
    v_cvt_pk_bf16_f32 v193, v172, v173
    v_pk_mul_f32 v[152:153], v[140:141], v[114:115] op_sel:[0,0] op_sel_hi:[1,0]
    v_pk_mul_f32 v[166:167], v[142:143], v[114:115] op_sel:[0,0] op_sel_hi:[1,0]
    v_pk_mul_f32 v[154:155], v[144:145], v[114:115] op_sel:[0,0] op_sel_hi:[1,0]
    v_pk_mul_f32 v[168:169], v[146:147], v[114:115] op_sel:[0,0] op_sel_hi:[1,0]
    v_pk_fma_f32 v[152:153], v[140:141], v[114:115], v[152:153] op_sel:[1,1,0] op_sel_hi:[0,1,1] neg_lo:[1,0,0]
    v_pk_fma_f32 v[166:167], v[142:143], v[114:115], v[166:167] op_sel:[1,1,0] op_sel_hi:[0,1,1] neg_lo:[1,0,0]
    v_pk_fma_f32 v[154:155], v[144:145], v[114:115], v[154:155] op_sel:[1,1,0] op_sel_hi:[0,1,1] neg_lo:[1,0,0]
    v_pk_fma_f32 v[168:169], v[146:147], v[114:115], v[168:169] op_sel:[1,1,0] op_sel_hi:[0,1,1] neg_lo:[1,0,0]
    v_cvt_pk_bf16_f32 v194, v146, v147
    v_cvt_pk_bf16_f32 v195, v174, v175
    v_cvt_pk_bf16_f32 v199, v150, v151
    v_cvt_pk_bf16_f32 v196, v176, v177
    ds_write2st64_b32 v81, v182, v199 offset0:2 offset1:18
    ds_write2st64_b32 v82, v183, v196 offset0:3 offset1:19
    v_pk_mul_f32 v[158:159], v[140:141], v[116:117] op_sel:[0,0] op_sel_hi:[1,0]
    v_pk_mul_f32 v[170:171], v[144:145], v[116:117] op_sel:[0,0] op_sel_hi:[1,0]
    v_pk_mul_f32 v[160:161], v[148:149], v[116:117] op_sel:[0,0] op_sel_hi:[1,0]
    v_pk_mul_f32 v[172:173], v[150:151], v[116:117] op_sel:[0,0] op_sel_hi:[1,0]
    v_pk_fma_f32 v[158:159], v[140:141], v[116:117], v[158:159] op_sel:[1,1,0] op_sel_hi:[0,1,1] neg_lo:[1,0,0]
    v_pk_fma_f32 v[170:171], v[144:145], v[116:117], v[170:171] op_sel:[1,1,0] op_sel_hi:[0,1,1] neg_lo:[1,0,0]
    v_pk_fma_f32 v[160:161], v[148:149], v[116:117], v[160:161] op_sel:[1,1,0] op_sel_hi:[0,1,1] neg_lo:[1,0,0]
    v_pk_fma_f32 v[172:173], v[150:151], v[116:117], v[172:173] op_sel:[1,1,0] op_sel_hi:[0,1,1] neg_lo:[1,0,0]
    v_cvt_pk_bf16_f32 v197, v178, v179
    v_cvt_pk_bf16_f32 v188, v164, v165
    v_cvt_pk_bf16_f32 v198, v152, v153
    v_cvt_pk_bf16_f32 v199, v166, v167
    ds_write2st64_b32 v88, v189, v197 offset0:9 offset1:25
    ds_write2st64_b32 v83, v184, v198 offset0:4 offset1:20
    ds_write2st64_b32 v84, v185, v199 offset0:5 offset1:21
    v_pk_mul_f32 v[162:163], v[152:153], v[116:117] op_sel:[0,0] op_sel_hi:[1,0]
    v_pk_mul_f32 v[174:175], v[154:155], v[116:117] op_sel:[0,0] op_sel_hi:[1,0]
    v_pk_mul_f32 v[176:177], v[140:141], v[118:119] op_sel:[0,0] op_sel_hi:[1,0]
    v_pk_mul_f32 v[178:179], v[148:149], v[118:119] op_sel:[0,0] op_sel_hi:[1,0]
    v_pk_fma_f32 v[162:163], v[152:153], v[116:117], v[162:163] op_sel:[1,1,0] op_sel_hi:[0,1,1] neg_lo:[1,0,0]
    v_pk_fma_f32 v[174:175], v[154:155], v[116:117], v[174:175] op_sel:[1,1,0] op_sel_hi:[0,1,1] neg_lo:[1,0,0]
    v_pk_fma_f32 v[176:177], v[140:141], v[118:119], v[176:177] op_sel:[1,1,0] op_sel_hi:[0,1,1] neg_lo:[1,0,0]
    v_pk_fma_f32 v[178:179], v[148:149], v[118:119], v[178:179] op_sel:[1,1,0] op_sel_hi:[0,1,1] neg_lo:[1,0,0]
    v_cvt_pk_bf16_f32 v196, v154, v155
    v_cvt_pk_bf16_f32 v197, v168, v169
    v_cvt_pk_bf16_f32 v198, v158, v159
    v_cvt_pk_bf16_f32 v199, v170, v171
    ds_write2st64_b32 v85, v186, v196 offset0:6 offset1:22
    ds_write2st64_b32 v86, v187, v197 offset0:7 offset1:23
    ds_write2st64_b32 v89, v190, v198 offset0:10 offset1:26
    ds_write2st64_b32 v90, v191, v199 offset0:11 offset1:27
    v_pk_mul_f32 v[164:165], v[152:153], v[118:119] op_sel:[0,0] op_sel_hi:[1,0]
    v_pk_mul_f32 v[166:167], v[156:157], v[118:119] op_sel:[0,0] op_sel_hi:[1,0]
    v_pk_mul_f32 v[168:169], v[158:159], v[118:119] op_sel:[0,0] op_sel_hi:[1,0]
    v_pk_mul_f32 v[170:171], v[160:161], v[118:119] op_sel:[0,0] op_sel_hi:[1,0]
    v_pk_fma_f32 v[164:165], v[152:153], v[118:119], v[164:165] op_sel:[1,1,0] op_sel_hi:[0,1,1] neg_lo:[1,0,0]
    v_pk_fma_f32 v[166:167], v[156:157], v[118:119], v[166:167] op_sel:[1,1,0] op_sel_hi:[0,1,1] neg_lo:[1,0,0]
    v_pk_fma_f32 v[168:169], v[158:159], v[118:119], v[168:169] op_sel:[1,1,0] op_sel_hi:[0,1,1] neg_lo:[1,0,0]
    v_pk_fma_f32 v[170:171], v[160:161], v[118:119], v[170:171] op_sel:[1,1,0] op_sel_hi:[0,1,1] neg_lo:[1,0,0]
    v_cvt_pk_bf16_f32 v196, v160, v161
    v_cvt_pk_bf16_f32 v197, v172, v173
    v_cvt_pk_bf16_f32 v198, v162, v163
    v_cvt_pk_bf16_f32 v199, v174, v175
    ds_write2st64_b32 v91, v192, v196 offset0:12 offset1:28
    ds_write2st64_b32 v92, v193, v197 offset0:13 offset1:29
    ds_write2st64_b32 v93, v194, v198 offset0:14 offset1:30
    ds_write2st64_b32 v94, v195, v199 offset0:15 offset1:31
    v_pk_mul_f32 v[172:173], v[162:163], v[118:119] op_sel:[0,0] op_sel_hi:[1,0]
    v_pk_fma_f32 v[172:173], v[162:163], v[118:119], v[172:173] op_sel:[1,1,0] op_sel_hi:[0,1,1] neg_lo:[1,0,0]
    v_cvt_pk_bf16_f32 v181, v176, v177
    v_cvt_pk_bf16_f32 v182, v178, v179
    v_cvt_pk_bf16_f32 v183, v164, v165
    v_cvt_pk_bf16_f32 v184, v166, v167
    v_cvt_pk_bf16_f32 v185, v168, v169
    v_cvt_pk_bf16_f32 v186, v170, v171
    v_cvt_pk_bf16_f32 v187, v172, v173
    ds_write_b32 v79, v180 offset:8192
    ds_write_b32 v80, v181 offset:8448
    ds_write_b32 v81, v182 offset:8704
    ds_write_b32 v82, v183 offset:8960
    ds_write_b32 v83, v184 offset:9216
    ds_write_b32 v84, v185 offset:9472
    ds_write_b32 v85, v186 offset:9728
    ds_write_b32 v86, v187 offset:9984
    ds_write_b32 v87, v188 offset:10240
    s_cmp_eq_u32 s28, 0
    s_cbranch_scc1 L_c_ul1b
    s_cmp_lg_u32 s39, 0
    s_cbranch_scc1 L_c_ul1a
    buffer_load_dwordx3 v[24:26], v32, s[52:55], s62 offen
    buffer_load_dwordx3 v[28:30], v32, s[52:55], s62 offen offset:1280
    s_branch L_c_ul1b
L_c_ul1a:
    buffer_load_dwordx3 v[244:246], v32, s[52:55], s62 offen
    buffer_load_dwordx3 v[248:250], v32, s[52:55], s62 offen offset:1280
L_c_ul1b:
    s_add_u32 s62, s62, 655360
    s_waitcnt lgkmcnt(0)
    ds_read_b128 v[124:127], v103 offset:0
    ds_read_b128 v[128:131], v103 offset:4096
    ds_read_b128 v[132:135], v103 offset:8192
    ds_read_b128 v[136:139], v95
    ds_read_b128 v[140:143], v97
    ds_read_b128 v[144:147], v99
    ds_read_b128 v[148:151], v101
    ds_read_b128 v[152:155], v104 offset:0
    ds_read_b128 v[156:159], v104 offset:4096
    ds_read_b128 v[160:163], v104 offset:8192
    ds_read_b128 v[164:167], v96
    ds_read_b128 v[168:171], v98
    ds_read_b128 v[172:175], v100
    ds_read_b128 v[176:179], v102
    s_waitcnt lgkmcnt(7)
    v_mfma_f32_16x16x32_bf16 v[36:39], v[136:139], v[124:127], 0
    v_mfma_f32_16x16x32_bf16 v[40:43], v[140:143], v[128:131], 0
    v_mfma_f32_16x16x32_bf16 v[44:47], v[144:147], v[128:131], 0
    v_mfma_f32_16x16x32_bf16 v[48:51], v[148:151], v[132:135], 0
    s_waitcnt lgkmcnt(0)
    v_mfma_f32_16x16x32_bf16 v[36:39], v[164:167], v[152:155], v[36:39]
    v_mfma_f32_16x16x32_bf16 v[40:43], v[168:171], v[156:159], v[40:43]
    v_mfma_f32_16x16x32_bf16 v[44:47], v[172:175], v[156:159], v[44:47]
    v_mfma_f32_16x16x32_bf16 v[48:51], v[176:179], v[160:163], v[48:51]
    v_cmp_gt_u32 vcc, 8, v2
    v_add_u32 v12, s56, v4
    s_add_u32 s56, s56, 24576
    s_add_u32 s39, s39, 1
    s_nop 5
    v_cndmask_b32 v40, v44, v40, vcc
    v_cndmask_b32 v41, v45, v41, vcc
    v_cndmask_b32 v42, v46, v42, vcc
    v_cndmask_b32 v43, v47, v43, vcc
    ds_write_b128 v12, v[36:39] offset:0
    ds_write_b128 v12, v[40:43] offset:1024
    ds_write_b128 v12, v[48:51] offset:2048
    s_cmp_lt_u32 s39, s26
    s_cbranch_scc1 L_c_pass
    s_cmp_eq_u32 s28, 0
    s_cbranch_scc1 L_c_nogate
    v_mov_b32 v166, 0
    v_mov_b32 v167, 0
    s_mov_b32 s30, 0x3f803f80
    s_waitcnt vmcnt(8)
    v_lshlrev_b32 v10, 16, v224
    v_and_b32 v11, s40, v224
    v_lshlrev_b32 v6, 16, v200
    v_and_b32 v7, s40, v200
    v_pk_mul_f32 v[6:7], v[6:7], v[10:11]
    v_cvt_pk_bf16_f32 v6, v6, v7
    v_dot2_f32_bf16 v166, v6, s30, v166
    v_lshlrev_b32 v8, 16, v212
    v_and_b32 v9, s40, v212
    v_pk_mul_f32 v[8:9], v[8:9], v[10:11]
    v_cvt_pk_bf16_f32 v8, v8, v9
    v_dot2_f32_bf16 v167, v8, s30, v167
    v_lshlrev_b32 v10, 16, v225
    v_and_b32 v11, s40, v225
    v_lshlrev_b32 v6, 16, v201
    v_and_b32 v7, s40, v201
    v_pk_mul_f32 v[6:7], v[6:7], v[10:11]
    v_cvt_pk_bf16_f32 v6, v6, v7
    v_dot2_f32_bf16 v166, v6, s30, v166
    v_lshlrev_b32 v8, 16, v213
    v_and_b32 v9, s40, v213
    v_pk_mul_f32 v[8:9], v[8:9], v[10:11]
    v_cvt_pk_bf16_f32 v8, v8, v9
    v_dot2_f32_bf16 v167, v8, s30, v167
    v_lshlrev_b32 v10, 16, v226
    v_and_b32 v11, s40, v226
    v_lshlrev_b32 v6, 16, v202
    v_and_b32 v7, s40, v202
    v_pk_mul_f32 v[6:7], v[6:7], v[10:11]
    v_cvt_pk_bf16_f32 v6, v6, v7
    v_dot2_f32_bf16 v166, v6, s30, v166
    v_lshlrev_b32 v8, 16, v214
    v_and_b32 v9, s40, v214
    v_pk_mul_f32 v[8:9], v[8:9], v[10:11]
    v_cvt_pk_bf16_f32 v8, v8, v9
    v_dot2_f32_bf16 v167, v8, s30, v167
    v_lshlrev_b32 v10, 16, v227
    v_and_b32 v11, s40, v227
    v_lshlrev_b32 v6, 16, v203
    v_and_b32 v7, s40, v203
    v_pk_mul_f32 v[6:7], v[6:7], v[10:11]
    v_cvt_pk_bf16_f32 v6, v6, v7
    v_dot2_f32_bf16 v166, v6, s30, v166
    v_lshlrev_b32 v8, 16, v215
    v_and_b32 v9, s40, v215
    v_pk_mul_f32 v[8:9], v[8:9], v[10:11]
    v_cvt_pk_bf16_f32 v8, v8, v9
    v_dot2_f32_bf16 v167, v8, s30, v167
    v_lshlrev_b32 v10, 16, v228
    v_and_b32 v11, s40, v228
    v_lshlrev_b32 v6, 16, v204
    v_and_b32 v7, s40, v204
    v_pk_mul_f32 v[6:7], v[6:7], v[10:11]
    v_cvt_pk_bf16_f32 v6, v6, v7
    v_dot2_f32_bf16 v166, v6, s30, v166
    v_lshlrev_b32 v8, 16, v216
    v_and_b32 v9, s40, v216
    v_pk_mul_f32 v[8:9], v[8:9], v[10:11]
    v_cvt_pk_bf16_f32 v8, v8, v9
    v_dot2_f32_bf16 v167, v8, s30, v167
    v_lshlrev_b32 v10, 16, v229
    v_and_b32 v11, s40, v229
    v_lshlrev_b32 v6, 16, v205
    v_and_b32 v7, s40, v205
    v_pk_mul_f32 v[6:7], v[6:7], v[10:11]
    v_cvt_pk_bf16_f32 v6, v6, v7
    v_dot2_f32_bf16 v166, v6, s30, v166
    v_lshlrev_b32 v8, 16, v217
    v_and_b32 v9, s40, v217
    v_pk_mul_f32 v[8:9], v[8:9], v[10:11]
    v_cvt_pk_bf16_f32 v8, v8, v9
    v_dot2_f32_bf16 v167, v8, s30, v167
    v_lshlrev_b32 v10, 16, v230
    v_and_b32 v11, s40, v230
    v_lshlrev_b32 v6, 16, v206
    v_and_b32 v7, s40, v206
    v_pk_mul_f32 v[6:7], v[6:7], v[10:11]
    v_cvt_pk_bf16_f32 v6, v6, v7
    v_dot2_f32_bf16 v166, v6, s30, v166
    v_lshlrev_b32 v8, 16, v218
    v_and_b32 v9, s40, v218
    v_pk_mul_f32 v[8:9], v[8:9], v[10:11]
    v_cvt_pk_bf16_f32 v8, v8, v9
    v_dot2_f32_bf16 v167, v8, s30, v167
    v_lshlrev_b32 v10, 16, v231
    v_and_b32 v11, s40, v231
    v_lshlrev_b32 v6, 16, v207
    v_and_b32 v7, s40, v207
    v_pk_mul_f32 v[6:7], v[6:7], v[10:11]
    v_cvt_pk_bf16_f32 v6, v6, v7
    v_dot2_f32_bf16 v166, v6, s30, v166
    v_lshlrev_b32 v8, 16, v219
    v_and_b32 v9, s40, v219
    v_pk_mul_f32 v[8:9], v[8:9], v[10:11]
    v_cvt_pk_bf16_f32 v8, v8, v9
    v_dot2_f32_bf16 v167, v8, s30, v167
    v_lshlrev_b32 v10, 16, v232
    v_and_b32 v11, s40, v232
    v_lshlrev_b32 v6, 16, v208
    v_and_b32 v7, s40, v208
    v_pk_mul_f32 v[6:7], v[6:7], v[10:11]
    v_cvt_pk_bf16_f32 v6, v6, v7
    v_dot2_f32_bf16 v166, v6, s30, v166
    v_lshlrev_b32 v8, 16, v220
    v_and_b32 v9, s40, v220
    v_pk_mul_f32 v[8:9], v[8:9], v[10:11]
    v_cvt_pk_bf16_f32 v8, v8, v9
    v_dot2_f32_bf16 v167, v8, s30, v167
    v_lshlrev_b32 v10, 16, v233
    v_and_b32 v11, s40, v233
    v_lshlrev_b32 v6, 16, v209
    v_and_b32 v7, s40, v209
    v_pk_mul_f32 v[6:7], v[6:7], v[10:11]
    v_cvt_pk_bf16_f32 v6, v6, v7
    v_dot2_f32_bf16 v166, v6, s30, v166
    v_lshlrev_b32 v8, 16, v221
    v_and_b32 v9, s40, v221
    v_pk_mul_f32 v[8:9], v[8:9], v[10:11]
    v_cvt_pk_bf16_f32 v8, v8, v9
    v_dot2_f32_bf16 v167, v8, s30, v167
    s_nop 2
    v_add_f32_dpp v166, v166, v166 row_shr:1 row_mask:0xf bank_mask:0xf bound_ctrl:0
    v_add_f32_dpp v167, v167, v167 row_shr:1 row_mask:0xf bank_mask:0xf bound_ctrl:0
    s_nop 1
    v_add_f32_dpp v166, v166, v166 row_shr:2 row_mask:0xf bank_mask:0xf bound_ctrl:0
    v_add_f32_dpp v167, v167, v167 row_shr:2 row_mask:0xf bank_mask:0xf bound_ctrl:0
    s_nop 1
    v_add_f32_dpp v166, v166, v166 row_shr:4 row_mask:0xf bank_mask:0xf bound_ctrl:0
    v_add_f32_dpp v167, v167, v167 row_shr:4 row_mask:0xf bank_mask:0xf bound_ctrl:0
    s_nop 1
    v_add_f32_dpp v166, v166, v166 row_shr:8 row_mask:0xf bank_mask:0xf bound_ctrl:0
    v_add_f32_dpp v167, v167, v167 row_shr:8 row_mask:0xf bank_mask:0xf bound_ctrl:0
    s_nop 1
    v_add_f32_dpp v166, v166, v166 row_bcast:15 row_mask:0xa bank_mask:0xf
    v_add_f32_dpp v167, v167, v167 row_bcast:15 row_mask:0xa bank_mask:0xf
    s_mov_b32 s31, 0x3fb8aa3b
    v_cvt_pk_bf16_f32 v166, v166, v166
    v_lshlrev_b32 v166, 16, v166
    v_mul_f32 v166, s31, v166
    v_exp_f32 v166, -v166
    s_nop 0
    v_add_f32 v166, 1.0, v166
    v_rcp_f32 v166, v166
    s_nop 0
    v_cvt_pk_bf16_f32 v166, v166, v166
    v_lshlrev_b32 v166, 16, v166
    v_cvt_pk_bf16_f32 v167, v167, v167
    v_lshlrev_b32 v167, 16, v167
    v_mul_f32 v167, s31, v167
    v_exp_f32 v167, -v167
    s_nop 0
    v_add_f32 v167, 1.0, v167
    v_rcp_f32 v167, v167
    s_nop 0
    v_cvt_pk_bf16_f32 v167, v167, v167
    v_lshlrev_b32 v167, 16, v167
    v_lshlrev_b32 v210, 2, v210
    s_mov_b32 s34, 0x80000000
    s_mov_b32 s35, 0x80000000
    s_mov_b32 s30, 131072
    s_mov_b64 exec, s[34:35]
    buffer_store_dword v166, v210, s[48:51], s30 offen sc1
    buffer_store_dword v167, v210, s[48:51], s30 offen offset:8 sc1
    s_mov_b64 exec, -1
L_c_nogate:
    s_setprio 0
    s_cmp_lg_u32 s28, 0
    s_cbranch_scc1 L_c_w1
    s_waitcnt vmcnt(0)
L_c_w1:
    s_waitcnt lgkmcnt(0)
    s_barrier
    v_lshlrev_b32 v7, 5, v2
    v_lshl_add_u32 v7, v3, 3, v7
    s_mov_b32 s33, 15
    s_mov_b32 s39, s25
L_c_red:
    s_mul_i32 s30, s39, 86
    s_lshr_b32 s30, s30, 8
    s_mul_i32 s31, s30, 3
    s_sub_u32 s31, s39, s31
    s_mul_i32 s32, s30, 12288
    s_lshl_b32 s34, s31, 10
    s_add_u32 s32, s32, s34
    s_add_u32 s32, s32, 90112
    v_add_u32 v8, s32, v4
    ds_read_b128 v[124:127], v8 offset:0
    ds_read_b128 v[128:131], v8 offset:3072
    ds_read_b128 v[132:135], v8 offset:6144
    ds_read_b128 v[136:139], v8 offset:9216
    s_mul_i32 s32, s30, 1600
    s_lshl_b32 s34, s31, 9
    s_add_u32 s32, s32, s34
    s_add_u32 s32, s32, 65280
    v_add_u32 v9, s32, v7
    s_add_u32 s39, s39, 8
    s_waitcnt lgkmcnt(0)
    v_pk_add_f32 v[124:125], v[124:125], v[128:129]
    v_pk_add_f32 v[132:133], v[132:133], v[136:137]
    v_pk_add_f32 v[126:127], v[126:127], v[130:131]
    v_pk_add_f32 v[134:135], v[134:135], v[138:139]
    v_pk_add_f32 v[124:125], v[124:125], v[132:133]
    v_pk_add_f32 v[126:127], v[126:127], v[134:135]
    v_cvt_pk_bf16_f32 v140, v124, v125
    v_cvt_pk_bf16_f32 v141, v126, v127
    ds_write_b64 v9, v[140:141] offset:32
    s_cmp_lt_u32 s39, s33
    s_cbranch_scc1 L_c_red
    v_mov_b32 v144, 0
    v_mov_b32 v145, 0
    v_mov_b32 v146, 0
    v_mov_b32 v147, 0
    s_cmp_lg_u32 s25, 7
    s_cbranch_scc1 L_c_nopad
    v_and_b32 v8, 1, v1
    v_lshlrev_b32 v8, 4, v8
    v_add_u32 v8, 65280, v8
    ds_write_b128 v8, v[144:147] offset:0
    ds_write_b128 v8, v[144:147] offset:1600
    ds_write_b128 v8, v[144:147] offset:3200
    ds_write_b128 v8, v[144:147] offset:4800
    ds_write_b128 v8, v[144:147] offset:6400
    v_and_b32 v8, 31, v1
    v_lshlrev_b32 v8, 4, v8
    ds_write_b128 v8, v[144:147] offset:0
    ds_write_b128 v8, v[144:147] offset:4608
    ds_write_b128 v8, v[144:147] offset:9216
    ds_write_b128 v8, v[144:147] offset:13824
    ds_write_b128 v8, v[144:147] offset:18432
L_c_nopad:
    s_waitcnt lgkmcnt(0)
    s_barrier
    s_mov_b32 s30, 0x01000100
    s_mov_b32 s31, 0x03020302
    s_mov_b32 s32, 0x07060100
    s_mov_b32 s33, 0x01000302
    s_mul_i32 s34, s28, 8448
    v_add_u32 v13, s34, v4
    s_mul_i32 s39, s28, 1600
    s_cmp_ge_u32 s27, 2
    s_cbranch_scc1 L_c_e2
    s_lshl_b32 s34, s27, 7
    s_sub_u32 s34, s39, s34
    s_add_u32 s34, s34, 66590
    v_lshlrev_b32 v6, 1, v1
    v_sub_u32 v6, s34, v6
    s_lshl_b32 s34, s27, 10
    v_add_u32 v13, s34, v13
    v_and_b32 v7, 1, v1
    v_cmp_eq_u32 vcc, 0, v7
    ds_read_u16 v124, v6 offset:2
    ds_read_u16 v128, v6 offset:0
    ds_read_u16 v125, v6 offset:3202
    ds_read_u16 v129, v6 offset:3200
    ds_read_u16 v126, v6 offset:6402
    ds_read_u16 v130, v6 offset:6400
    s_waitcnt lgkmcnt(0)
    v_lshl_or_b32 v124, v128, 16, v124
    v_perm_b32 v132, v124, v124, s30
    v_perm_b32 v135, v124, v124, s31
    v_mov_b32 v133, v132
    v_cndmask_b32 v134, v135, v124, vcc
    v_mov_b32 v136, v132
    v_cndmask_b32 v137, v124, v132, vcc
    v_mov_b32 v138, v135
    v_mov_b32 v139, v135
    ds_write_b128 v13, v[132:135] offset:23040
    ds_write_b128 v13, v[136:139] offset:27200
    v_lshl_or_b32 v125, v129, 16, v125
    v_perm_b32 v140, v125, v125, s30
    v_perm_b32 v143, v125, v125, s31
    v_mov_b32 v141, v140
    v_cndmask_b32 v142, v143, v125, vcc
    v_mov_b32 v144, v140
    v_cndmask_b32 v145, v125, v140, vcc
    v_mov_b32 v146, v143
    v_mov_b32 v147, v143
    ds_write_b128 v13, v[140:143] offset:39936
    ds_write_b128 v13, v[144:147] offset:44096
    s_cmp_lt_u32 s26, 3
    s_cbranch_scc1 L_c_e9
    v_lshl_or_b32 v126, v130, 16, v126
    v_perm_b32 v148, v126, v126, s30
    v_perm_b32 v151, v126, v126, s31
    v_mov_b32 v149, v148
    v_cndmask_b32 v150, v151, v126, vcc
    v_mov_b32 v152, v148
    v_cndmask_b32 v153, v126, v148, vcc
    v_mov_b32 v154, v151
    v_mov_b32 v155, v151
    ds_write_b128 v13, v[148:151] offset:56832
    ds_write_b128 v13, v[152:155] offset:60992
    s_branch L_c_e9
L_c_e2:
    s_cmp_eq_u32 s27, 3
    s_cbranch_scc1 L_c_e3
    s_add_u32 s34, s39, 66332
    v_lshlrev_b32 v6, 2, v1
    v_sub_u32 v6, s34, v6
    ds_read_u16 v124, v6 offset:4
    ds_read_b32 v128, v6 offset:0
    ds_read_u16 v125, v6 offset:3204
    ds_read_b32 v129, v6 offset:3200
    ds_read_u16 v126, v6 offset:6404
    ds_read_b32 v130, v6 offset:6400
    s_waitcnt lgkmcnt(0)
    v_perm_b32 v132, v124, v124, s30
    v_perm_b32 v133, v128, v124, s32
    v_perm_b32 v134, v128, v128, s31
    v_perm_b32 v135, v128, v128, s30
    v_mov_b32 v136, v132
    v_mov_b32 v137, v134
    v_perm_b32 v138, v128, v128, s33
    v_mov_b32 v139, v135
    ds_write_b128 v13, v[132:135] offset:25088
    ds_write_b128 v13, v[136:139] offset:29248
    v_perm_b32 v140, v125, v125, s30
    v_perm_b32 v141, v129, v125, s32
    v_perm_b32 v142, v129, v129, s31
    v_perm_b32 v143, v129, v129, s30
    v_mov_b32 v144, v140
    v_mov_b32 v145, v142
    v_perm_b32 v146, v129, v129, s33
    v_mov_b32 v147, v143
    ds_write_b128 v13, v[140:143] offset:41984
    ds_write_b128 v13, v[144:147] offset:46144
    s_cmp_lt_u32 s26, 3
    s_cbranch_scc1 L_c_e9
    v_perm_b32 v148, v126, v126, s30
    v_perm_b32 v149, v130, v126, s32
    v_perm_b32 v150, v130, v130, s31
    v_perm_b32 v151, v130, v130, s30
    v_mov_b32 v152, v148
    v_mov_b32 v153, v150
    v_perm_b32 v154, v130, v130, s33
    v_mov_b32 v155, v151
    ds_write_b128 v13, v[148:151] offset:58880
    ds_write_b128 v13, v[152:155] offset:63040
    s_branch L_c_e9
L_c_e3:
    s_add_u32 s34, s39, 66072
    v_lshlrev_b32 v7, 3, v1
    v_sub_u32 v7, s34, v7
    s_add_u32 s34, s39, 65808
    v_min_u32 v8, 33, v1
    v_lshlrev_b32 v8, 4, v8
    v_sub_u32 v8, s34, v8
    s_mov_b32 s34, -1
    s_mov_b32 s35, 3
    ds_read_u16 v124, v7 offset:8
    ds_read_b64 v[126:127], v7 offset:0
    ds_read_u16 v125, v8 offset:16
    ds_read_b128 v[128:131], v8 offset:0
    s_waitcnt lgkmcnt(0)
    v_perm_b32 v132, v124, v124, s30
    v_perm_b32 v133, v127, v127, s33
    v_perm_b32 v134, v127, v127, s30
    v_perm_b32 v135, v126, v126, s33
    v_perm_b32 v136, v127, v124, s32
    v_mov_b32 v137, v134
    v_perm_b32 v138, v126, v127, s32
    v_perm_b32 v139, v126, v126, s30
    v_perm_b32 v140, v131, v125, s32
    v_perm_b32 v141, v130, v131, s32
    v_perm_b32 v142, v129, v130, s32
    v_perm_b32 v143, v128, v129, s32
    v_perm_b32 v144, v131, v131, s33
    v_perm_b32 v145, v130, v130, s33
    v_perm_b32 v146, v129, v129, s33
    v_perm_b32 v147, v128, v128, s33
    s_mov_b64 exec, 0xffffffff
    ds_write_b128 v13, v[132:135] offset:26112
    ds_write_b128 v13, v[136:139] offset:30272
    s_mov_b64 exec, s[34:35]
    ds_write_b128 v13, v[140:143] offset:26624
    ds_write_b128 v13, v[144:147] offset:30784
    s_mov_b64 exec, -1
    ds_read_u16 v124, v7 offset:3208
    ds_read_b64 v[126:127], v7 offset:3200
    ds_read_u16 v125, v8 offset:3216
    ds_read_b128 v[128:131], v8 offset:3200
    s_waitcnt lgkmcnt(0)
    v_perm_b32 v132, v124, v124, s30
    v_perm_b32 v133, v127, v127, s33
    v_perm_b32 v134, v127, v127, s30
    v_perm_b32 v135, v126, v126, s33
    v_perm_b32 v136, v127, v124, s32
    v_mov_b32 v137, v134
    v_perm_b32 v138, v126, v127, s32
    v_perm_b32 v139, v126, v126, s30
    v_perm_b32 v140, v131, v125, s32
    v_perm_b32 v141, v130, v131, s32
    v_perm_b32 v142, v129, v130, s32
    v_perm_b32 v143, v128, v129, s32
    v_perm_b32 v144, v131, v131, s33
    v_perm_b32 v145, v130, v130, s33
    v_perm_b32 v146, v129, v129, s33
    v_perm_b32 v147, v128, v128, s33
    s_mov_b64 exec, 0xffffffff
    ds_write_b128 v13, v[132:135] offset:43008
    ds_write_b128 v13, v[136:139] offset:47168
    s_mov_b64 exec, s[34:35]
    ds_write_b128 v13, v[140:143] offset:43520
    ds_write_b128 v13, v[144:147] offset:47680
    s_mov_b64 exec, -1
    s_cmp_lt_u32 s26, 3
    s_cbranch_scc1 L_c_e9
    ds_read_u16 v124, v7 offset:6408
    ds_read_b64 v[126:127], v7 offset:6400
    ds_read_u16 v125, v8 offset:6416
    ds_read_b128 v[128:131], v8 offset:6400
    s_waitcnt lgkmcnt(0)
    v_perm_b32 v132, v124, v124, s30
    v_perm_b32 v133, v127, v127, s33
    v_perm_b32 v134, v127, v127, s30
    v_perm_b32 v135, v126, v126, s33
    v_perm_b32 v136, v127, v124, s32
    v_mov_b32 v137, v134
    v_perm_b32 v138, v126, v127, s32
    v_perm_b32 v139, v126, v126, s30
    v_perm_b32 v140, v131, v125, s32
    v_perm_b32 v141, v130, v131, s32
    v_perm_b32 v142, v129, v130, s32
    v_perm_b32 v143, v128, v129, s32
    v_perm_b32 v144, v131, v131, s33
    v_perm_b32 v145, v130, v130, s33
    v_perm_b32 v146, v129, v129, s33
    v_perm_b32 v147, v128, v128, s33
    s_mov_b64 exec, 0xffffffff
    ds_write_b128 v13, v[132:135] offset:59904
    ds_write_b128 v13, v[136:139] offset:64064
    s_mov_b64 exec, s[34:35]
    ds_write_b128 v13, v[140:143] offset:60416
    ds_write_b128 v13, v[144:147] offset:64576
    s_mov_b64 exec, -1
L_c_e9:
    s_cmp_ge_u32 s68, 80
    s_cbranch_scc1 L_c_nowof
    s_add_u32 s31, s25, 4
    s_and_b32 s31, s31, 7
    s_cmp_eq_u32 s31, 3
    s_cbranch_scc1 L_c_nowof
    s_cmp_ge_u32 s31, 6
    s_cbranch_scc1 L_c_nowof
    s_cmp_ge_u32 s31, 4
    s_cselect_b32 s30, 1, 0
    s_sub_u32 s31, s31, s30
    v_lshrrev_b32 v6, 2, v2
    v_and_b32 v7, 3, v2
    v_lshlrev_b32 v7, 4, v7
    v_add_u32 v7, 151552, v7
    s_lshl_b32 s32, s31, 3
    v_add_u32 v6, s32, v6
    v_add_u32 v11, 16, v3
    v_add_u32 v8, 0, v6
    v_mul_u32_u24 v9, 205, v8
    v_lshrrev_b32 v9, 10, v9
    v_mul_u32_u24 v10, 5, v9
    v_sub_u32 v8, v8, v10
    v_cmp_eq_u32 vcc, 4, v8
    v_lshl_add_u32 v10, v3, 2, v8
    v_mul_u32_u24 v9, 20, v9
    v_cndmask_b32 v10, v10, v11, vcc
    v_add_u32 v10, v9, v10
    v_lshl_add_u32 v10, v10, 6, v7
    ds_read_b64_tr_b16 v[180:181], v10 offset:0
    ds_read_b64_tr_b16 v[184:185], v10 offset:8
    v_add_u32 v8, 4, v6
    v_mul_u32_u24 v9, 205, v8
    v_lshrrev_b32 v9, 10, v9
    v_mul_u32_u24 v10, 5, v9
    v_sub_u32 v8, v8, v10
    v_cmp_eq_u32 vcc, 4, v8
    v_lshl_add_u32 v10, v3, 2, v8
    v_mul_u32_u24 v9, 20, v9
    v_cndmask_b32 v10, v10, v11, vcc
    v_add_u32 v10, v9, v10
    v_lshl_add_u32 v10, v10, 6, v7
    ds_read_b64_tr_b16 v[182:183], v10 offset:0
    ds_read_b64_tr_b16 v[186:187], v10 offset:8
    s_lshr_b32 s32, s68, 2
    s_mul_i32 s32, s32, 40
    s_and_b32 s33, s68, 3
    s_mul_i32 s33, s33, 5
    s_add_u32 s32, s32, s33
    s_add_u32 s32, s32, s31
    s_lshl_b32 s32, s32, 10
    s_add_u32 s32, s32, 262144
    s_add_u32 s33, s32, 20480
    s_waitcnt vmcnt(0) lgkmcnt(0)
    buffer_store_dwordx4 v[180:183], v4, s[48:51], s32 offen sc1
    buffer_store_dwordx4 v[184:187], v4, s[48:51], s33 offen sc1
    s_branch L_c_ustage
L_c_nowof:
    s_waitcnt vmcnt(0)
L_c_ustage:
    s_cmp_eq_u32 s28, 0
    s_cbranch_scc1 L_c_nostage
    s_and_b32 s30, s24, 1
    s_cmp_eq_u32 s30, 0
    s_cbranch_scc1 L_c_even
    v_alignbit_b32 v16, v17, v16, 16
    v_alignbit_b32 v17, v18, v17, 16
    v_lshrrev_b32 v18, 16, v18
    v_alignbit_b32 v20, v21, v20, 16
    v_alignbit_b32 v21, v22, v21, 16
    v_lshrrev_b32 v22, 16, v22
    v_alignbit_b32 v24, v25, v24, 16
    v_alignbit_b32 v25, v26, v25, 16
    v_lshrrev_b32 v26, 16, v26
    v_alignbit_b32 v28, v29, v28, 16
    v_alignbit_b32 v29, v30, v29, 16
    v_lshrrev_b32 v30, 16, v30
    v_alignbit_b32 v236, v237, v236, 16
    v_alignbit_b32 v237, v238, v237, 16
    v_lshrrev_b32 v238, 16, v238
    v_alignbit_b32 v240, v241, v240, 16
    v_alignbit_b32 v241, v242, v241, 16
    v_lshrrev_b32 v242, 16, v242
    v_alignbit_b32 v244, v245, v244, 16
    v_alignbit_b32 v245, v246, v245, 16
    v_lshrrev_b32 v246, 16, v246
    v_alignbit_b32 v248, v249, v248, 16
    v_alignbit_b32 v249, v250, v249, 16
    v_lshrrev_b32 v250, 16, v250
L_c_even:
    s_mov_b32 s30, 0x05040100
    s_mov_b32 s31, 0x07060302
    v_and_b32 v8, 255, v0
    v_lshlrev_b32 v8, 2, v8
    v_perm_b32 v124, v20, v16, s30
    v_perm_b32 v125, v20, v16, s31
    v_perm_b32 v126, v21, v17, s30
    v_perm_b32 v127, v21, v17, s31
    v_perm_b32 v128, v22, v18, s30
    v_perm_b32 v129, v28, v24, s30
    v_perm_b32 v130, v28, v24, s31
    v_perm_b32 v131, v29, v25, s30
    v_perm_b32 v132, v29, v25, s31
    v_perm_b32 v133, v30, v26, s30
    v_perm_b32 v134, v240, v236, s30
    v_perm_b32 v135, v240, v236, s31
    v_perm_b32 v136, v241, v237, s30
    v_perm_b32 v137, v241, v237, s31
    v_perm_b32 v138, v242, v238, s30
    v_perm_b32 v139, v248, v244, s30
    v_perm_b32 v140, v248, v244, s31
    v_perm_b32 v141, v249, v245, s30
    v_perm_b32 v142, v249, v245, s31
    v_perm_b32 v143, v250, v246, s30
    ds_write_b32 v8, v124 offset:512
    ds_write_b32 v8, v125 offset:5120
    ds_write_b32 v8, v126 offset:9728
    ds_write_b32 v8, v127 offset:14336
    ds_write_b32 v8, v128 offset:18944
    ds_write_b32 v8, v129 offset:1536
    ds_write_b32 v8, v130 offset:6144
    ds_write_b32 v8, v131 offset:10752
    ds_write_b32 v8, v132 offset:15360
    ds_write_b32 v8, v133 offset:19968
    ds_write_b32 v8, v134 offset:2560
    ds_write_b32 v8, v135 offset:7168
    ds_write_b32 v8, v136 offset:11776
    ds_write_b32 v8, v137 offset:16384
    ds_write_b32 v8, v138 offset:20992
    ds_write_b32 v8, v139 offset:3584
    ds_write_b32 v8, v140 offset:8192
    ds_write_b32 v8, v141 offset:12800
    ds_write_b32 v8, v142 offset:17408
    ds_write_b32 v8, v143 offset:22016
L_c_nostage:
    s_mul_i32 s30, s25, 5
    s_lshr_b32 s31, s30, 3
    s_and_b32 s56, s30, 7
    s_add_u32 s57, s25, s31
    v_and_b32 v6, 1, v2
    v_add_u32 v7, v2, v6
    v_lshlrev_b32 v9, 3, v3
    v_sub_u32 v9, v9, v7
    v_lshlrev_b32 v9, 1, v9
    s_movk_i32 s30, 4160
    v_mad_u32_u24 v9, v6, s30, v9
    s_lshl_b32 s30, s56, 6
    s_mul_i32 s32, s31, 8448
    s_sub_u32 s32, s32, s30
    s_add_u32 s33, s32, 26592
    v_add_u32 v24, s33, v9
    s_add_u32 s33, s32, 25568
    v_add_u32 v25, s33, v9
    s_add_u32 s33, s32, 24544
    v_add_u32 v26, s33, v9
    s_add_u32 s33, s32, 23520
    v_add_u32 v27, s33, v9
    v_lshlrev_b32 v6, 5, v2
    v_lshl_add_u32 v6, v3, 4, v6
    s_mul_i32 s32, s31, 4608
    s_sub_u32 s32, s32, s30
    s_add_u32 s32, s32, 480
    v_add_u32 v28, s32, v6
    s_lshl_b32 s32, s57, 13
    s_add_u32 s32, s32, 65536
    v_add_u32 v29, s32, v4
    v_mov_b32 v36, 0
    v_mov_b32 v37, 0
    v_mov_b32 v38, 0
    v_mov_b32 v39, 0
    v_mov_b32 v40, 0
    v_mov_b32 v41, 0
    v_mov_b32 v42, 0
    v_mov_b32 v43, 0
    v_mov_b32 v44, 0
    v_mov_b32 v45, 0
    v_mov_b32 v46, 0
    v_mov_b32 v47, 0
    v_mov_b32 v48, 0
    v_mov_b32 v49, 0
    v_mov_b32 v50, 0
    v_mov_b32 v51, 0
    v_mov_b32 v52, 0
    v_mov_b32 v53, 0
    v_mov_b32 v54, 0
    v_mov_b32 v55, 0
    v_mov_b32 v56, 0
    v_mov_b32 v57, 0
    v_mov_b32 v58, 0
    v_mov_b32 v59, 0
    v_mov_b32 v60, 0
    v_mov_b32 v61, 0
    v_mov_b32 v62, 0
    v_mov_b32 v63, 0
    v_mov_b32 v64, 0
    v_mov_b32 v65, 0
    v_mov_b32 v66, 0
    v_mov_b32 v67, 0
    s_mov_b32 s39, 0
    s_mov_b32 s33, -64
    s_waitcnt lgkmcnt(0)
    s_barrier
    ds_read_b128 v[132:135], v28 offset:0
    ds_read_b128 v[136:139], v28 offset:512
    ds_read_b128 v[140:143], v28 offset:1024
    ds_read_b128 v[144:147], v28 offset:1536
    ds_read_b128 v[148:151], v28 offset:2048
    ds_read_b128 v[152:155], v28 offset:2560
    ds_read_b128 v[156:159], v28 offset:3072
    ds_read_b128 v[160:163], v28 offset:3584
    ds_read2_b32 v[68:69], v24 offset0:128 offset1:129
    ds_read2_b32 v[70:71], v24 offset0:130 offset1:131
    ds_read2_b32 v[72:73], v24 offset0:0 offset1:1
    ds_read2_b32 v[74:75], v24 offset0:2 offset1:3
    ds_read2_b32 v[76:77], v25 offset0:128 offset1:129
    ds_read2_b32 v[78:79], v25 offset0:130 offset1:131
    ds_read2_b32 v[80:81], v25 offset0:0 offset1:1
    ds_read2_b32 v[82:83], v25 offset0:2 offset1:3
    ds_read2_b32 v[84:85], v26 offset0:128 offset1:129
    ds_read2_b32 v[86:87], v26 offset0:130 offset1:131
    ds_read2_b32 v[88:89], v26 offset0:0 offset1:1
    ds_read2_b32 v[90:91], v26 offset0:2 offset1:3
    ds_read2_b32 v[92:93], v27 offset0:128 offset1:129
    ds_read2_b32 v[94:95], v27 offset0:130 offset1:131
    ds_read2_b32 v[96:97], v27 offset0:0 offset1:1
    ds_read2_b32 v[98:99], v27 offset0:2 offset1:3
L_c_loop:
    s_add_u32 s56, s56, 1
    s_cmp_eq_u32 s56, 8
    s_cselect_b32 s30, 8896, s33
    s_cselect_b32 s31, 5056, s33
    v_add_u32 v24, s30, v24
    v_add_u32 v25, s30, v25
    v_add_u32 v26, s30, v26
    v_add_u32 v27, s30, v27
    v_add_u32 v28, s31, v28
    s_add_u32 s39, s39, 1
    s_waitcnt lgkmcnt(0)
    v_mfma_f32_16x16x32_bf16 v[36:39], v[68:71], v[132:135], v[36:39]
    ds_read_b128 v[164:167], v28 offset:0
    v_mfma_f32_16x16x32_bf16 v[40:43], v[68:71], v[136:139], v[40:43]
    ds_read_b128 v[168:171], v28 offset:512
    v_mfma_f32_16x16x32_bf16 v[44:47], v[68:71], v[140:143], v[44:47]
    ds_read_b128 v[172:175], v28 offset:1024
    v_mfma_f32_16x16x32_bf16 v[48:51], v[68:71], v[144:147], v[48:51]
    ds_read_b128 v[176:179], v28 offset:1536
    v_mfma_f32_16x16x32_bf16 v[52:55], v[68:71], v[148:151], v[52:55]
    ds_read_b128 v[180:183], v28 offset:2048
    v_mfma_f32_16x16x32_bf16 v[56:59], v[68:71], v[152:155], v[56:59]
    ds_read_b128 v[184:187], v28 offset:2560
    v_mfma_f32_16x16x32_bf16 v[60:63], v[68:71], v[156:159], v[60:63]
    ds_read_b128 v[188:191], v28 offset:3072
    v_mfma_f32_16x16x32_bf16 v[64:67], v[68:71], v[160:163], v[64:67]
    ds_read_b128 v[192:195], v28 offset:3584
    v_mfma_f32_16x16x32_bf16 v[40:43], v[72:75], v[132:135], v[40:43]
    ds_read2_b32 v[100:101], v24 offset0:128 offset1:129
    v_mfma_f32_16x16x32_bf16 v[44:47], v[72:75], v[136:139], v[44:47]
    ds_read2_b32 v[102:103], v24 offset0:130 offset1:131
    v_mfma_f32_16x16x32_bf16 v[48:51], v[72:75], v[140:143], v[48:51]
    ds_read2_b32 v[104:105], v24 offset0:0 offset1:1
    v_mfma_f32_16x16x32_bf16 v[52:55], v[72:75], v[144:147], v[52:55]
    ds_read2_b32 v[106:107], v24 offset0:2 offset1:3
    v_mfma_f32_16x16x32_bf16 v[56:59], v[72:75], v[148:151], v[56:59]
    ds_read2_b32 v[108:109], v25 offset0:128 offset1:129
    v_mfma_f32_16x16x32_bf16 v[60:63], v[72:75], v[152:155], v[60:63]
    ds_read2_b32 v[110:111], v25 offset0:130 offset1:131
    v_mfma_f32_16x16x32_bf16 v[64:67], v[72:75], v[156:159], v[64:67]
    ds_read2_b32 v[112:113], v25 offset0:0 offset1:1
    v_mfma_f32_16x16x32_bf16 v[44:47], v[76:79], v[132:135], v[44:47]
    ds_read2_b32 v[114:115], v25 offset0:2 offset1:3
    v_mfma_f32_16x16x32_bf16 v[48:51], v[76:79], v[136:139], v[48:51]
    ds_read2_b32 v[116:117], v26 offset0:128 offset1:129
    v_mfma_f32_16x16x32_bf16 v[52:55], v[76:79], v[140:143], v[52:55]
    ds_read2_b32 v[118:119], v26 offset0:130 offset1:131
    v_mfma_f32_16x16x32_bf16 v[56:59], v[76:79], v[144:147], v[56:59]
    ds_read2_b32 v[120:121], v26 offset0:0 offset1:1
    v_mfma_f32_16x16x32_bf16 v[60:63], v[76:79], v[148:151], v[60:63]
    ds_read2_b32 v[122:123], v26 offset0:2 offset1:3
    v_mfma_f32_16x16x32_bf16 v[64:67], v[76:79], v[152:155], v[64:67]
    ds_read2_b32 v[124:125], v27 offset0:128 offset1:129
    v_mfma_f32_16x16x32_bf16 v[48:51], v[80:83], v[132:135], v[48:51]
    ds_read2_b32 v[126:127], v27 offset0:130 offset1:131
    v_mfma_f32_16x16x32_bf16 v[52:55], v[80:83], v[136:139], v[52:55]
    ds_read2_b32 v[128:129], v27 offset0:0 offset1:1
    v_mfma_f32_16x16x32_bf16 v[56:59], v[80:83], v[140:143], v[56:59]
    ds_read2_b32 v[130:131], v27 offset0:2 offset1:3
    v_mfma_f32_16x16x32_bf16 v[60:63], v[80:83], v[144:147], v[60:63]
    v_mfma_f32_16x16x32_bf16 v[64:67], v[80:83], v[148:151], v[64:67]
    v_mfma_f32_16x16x32_bf16 v[52:55], v[84:87], v[132:135], v[52:55]
    v_mfma_f32_16x16x32_bf16 v[56:59], v[84:87], v[136:139], v[56:59]
    v_mfma_f32_16x16x32_bf16 v[60:63], v[84:87], v[140:143], v[60:63]
    v_mfma_f32_16x16x32_bf16 v[64:67], v[84:87], v[144:147], v[64:67]
    v_mfma_f32_16x16x32_bf16 v[56:59], v[88:91], v[132:135], v[56:59]
    v_mfma_f32_16x16x32_bf16 v[60:63], v[88:91], v[136:139], v[60:63]
    v_mfma_f32_16x16x32_bf16 v[64:67], v[88:91], v[140:143], v[64:67]
    v_mfma_f32_16x16x32_bf16 v[60:63], v[92:95], v[132:135], v[60:63]
    v_mfma_f32_16x16x32_bf16 v[64:67], v[92:95], v[136:139], v[64:67]
    v_mfma_f32_16x16x32_bf16 v[64:67], v[96:99], v[132:135], v[64:67]
    s_cmp_eq_u32 s39, 5
    s_cbranch_scc1 L_c_dump0
    s_cmp_lg_u32 s56, 8
    s_cbranch_scc1 L_c_next0
L_c_dump0:
    s_nop 7
    ds_write_b128 v29, v[36:39] offset:0
    ds_write_b128 v29, v[40:43] offset:1024
    ds_write_b128 v29, v[44:47] offset:2048
    ds_write_b128 v29, v[48:51] offset:3072
    ds_write_b128 v29, v[52:55] offset:4096
    ds_write_b128 v29, v[56:59] offset:5120
    ds_write_b128 v29, v[60:63] offset:6144
    ds_write_b128 v29, v[64:67] offset:7168
    s_cmp_eq_u32 s39, 5
    s_cbranch_scc1 L_c_convdone
    s_mov_b32 s56, 0
    v_add_u32 v29, 8192, v29
    v_mov_b32 v36, 0
    v_mov_b32 v37, 0
    v_mov_b32 v38, 0
    v_mov_b32 v39, 0
    v_mov_b32 v40, 0
    v_mov_b32 v41, 0
    v_mov_b32 v42, 0
    v_mov_b32 v43, 0
    v_mov_b32 v44, 0
    v_mov_b32 v45, 0
    v_mov_b32 v46, 0
    v_mov_b32 v47, 0
    v_mov_b32 v48, 0
    v_mov_b32 v49, 0
    v_mov_b32 v50, 0
    v_mov_b32 v51, 0
    v_mov_b32 v52, 0
    v_mov_b32 v53, 0
    v_mov_b32 v54, 0
    v_mov_b32 v55, 0
    v_mov_b32 v56, 0
    v_mov_b32 v57, 0
    v_mov_b32 v58, 0
    v_mov_b32 v59, 0
    v_mov_b32 v60, 0
    v_mov_b32 v61, 0
    v_mov_b32 v62, 0
    v_mov_b32 v63, 0
    v_mov_b32 v64, 0
    v_mov_b32 v65, 0
    v_mov_b32 v66, 0
    v_mov_b32 v67, 0
L_c_next0:
    s_add_u32 s56, s56, 1
    s_cmp_eq_u32 s56, 8
    s_cselect_b32 s30, 8896, s33
    s_cselect_b32 s31, 5056, s33
    v_add_u32 v24, s30, v24
    v_add_u32 v25, s30, v25
    v_add_u32 v26, s30, v26
    v_add_u32 v27, s30, v27
    v_add_u32 v28, s31, v28
    s_add_u32 s39, s39, 1
    s_waitcnt lgkmcnt(0)
    v_mfma_f32_16x16x32_bf16 v[36:39], v[100:103], v[164:167], v[36:39]
    ds_read_b128 v[132:135], v28 offset:0
    v_mfma_f32_16x16x32_bf16 v[40:43], v[100:103], v[168:171], v[40:43]
    ds_read_b128 v[136:139], v28 offset:512
    v_mfma_f32_16x16x32_bf16 v[44:47], v[100:103], v[172:175], v[44:47]
    ds_read_b128 v[140:143], v28 offset:1024
    v_mfma_f32_16x16x32_bf16 v[48:51], v[100:103], v[176:179], v[48:51]
    ds_read_b128 v[144:147], v28 offset:1536
    v_mfma_f32_16x16x32_bf16 v[52:55], v[100:103], v[180:183], v[52:55]
    ds_read_b128 v[148:151], v28 offset:2048
    v_mfma_f32_16x16x32_bf16 v[56:59], v[100:103], v[184:187], v[56:59]
    ds_read_b128 v[152:155], v28 offset:2560
    v_mfma_f32_16x16x32_bf16 v[60:63], v[100:103], v[188:191], v[60:63]
    ds_read_b128 v[156:159], v28 offset:3072
    v_mfma_f32_16x16x32_bf16 v[64:67], v[100:103], v[192:195], v[64:67]
    ds_read_b128 v[160:163], v28 offset:3584
    v_mfma_f32_16x16x32_bf16 v[40:43], v[104:107], v[164:167], v[40:43]
    ds_read2_b32 v[68:69], v24 offset0:128 offset1:129
    v_mfma_f32_16x16x32_bf16 v[44:47], v[104:107], v[168:171], v[44:47]
    ds_read2_b32 v[70:71], v24 offset0:130 offset1:131
    v_mfma_f32_16x16x32_bf16 v[48:51], v[104:107], v[172:175], v[48:51]
    ds_read2_b32 v[72:73], v24 offset0:0 offset1:1
    v_mfma_f32_16x16x32_bf16 v[52:55], v[104:107], v[176:179], v[52:55]
    ds_read2_b32 v[74:75], v24 offset0:2 offset1:3
    v_mfma_f32_16x16x32_bf16 v[56:59], v[104:107], v[180:183], v[56:59]
    ds_read2_b32 v[76:77], v25 offset0:128 offset1:129
    v_mfma_f32_16x16x32_bf16 v[60:63], v[104:107], v[184:187], v[60:63]
    ds_read2_b32 v[78:79], v25 offset0:130 offset1:131
    v_mfma_f32_16x16x32_bf16 v[64:67], v[104:107], v[188:191], v[64:67]
    ds_read2_b32 v[80:81], v25 offset0:0 offset1:1
    v_mfma_f32_16x16x32_bf16 v[44:47], v[108:111], v[164:167], v[44:47]
    ds_read2_b32 v[82:83], v25 offset0:2 offset1:3
    v_mfma_f32_16x16x32_bf16 v[48:51], v[108:111], v[168:171], v[48:51]
    ds_read2_b32 v[84:85], v26 offset0:128 offset1:129
    v_mfma_f32_16x16x32_bf16 v[52:55], v[108:111], v[172:175], v[52:55]
    ds_read2_b32 v[86:87], v26 offset0:130 offset1:131
    v_mfma_f32_16x16x32_bf16 v[56:59], v[108:111], v[176:179], v[56:59]
    ds_read2_b32 v[88:89], v26 offset0:0 offset1:1
    v_mfma_f32_16x16x32_bf16 v[60:63], v[108:111], v[180:183], v[60:63]
    ds_read2_b32 v[90:91], v26 offset0:2 offset1:3
    v_mfma_f32_16x16x32_bf16 v[64:67], v[108:111], v[184:187], v[64:67]
    ds_read2_b32 v[92:93], v27 offset0:128 offset1:129
    v_mfma_f32_16x16x32_bf16 v[48:51], v[112:115], v[164:167], v[48:51]
    ds_read2_b32 v[94:95], v27 offset0:130 offset1:131
    v_mfma_f32_16x16x32_bf16 v[52:55], v[112:115], v[168:171], v[52:55]
    ds_read2_b32 v[96:97], v27 offset0:0 offset1:1
    v_mfma_f32_16x16x32_bf16 v[56:59], v[112:115], v[172:175], v[56:59]
    ds_read2_b32 v[98:99], v27 offset0:2 offset1:3
    v_mfma_f32_16x16x32_bf16 v[60:63], v[112:115], v[176:179], v[60:63]
    v_mfma_f32_16x16x32_bf16 v[64:67], v[112:115], v[180:183], v[64:67]
    v_mfma_f32_16x16x32_bf16 v[52:55], v[116:119], v[164:167], v[52:55]
    v_mfma_f32_16x16x32_bf16 v[56:59], v[116:119], v[168:171], v[56:59]
    v_mfma_f32_16x16x32_bf16 v[60:63], v[116:119], v[172:175], v[60:63]
    v_mfma_f32_16x16x32_bf16 v[64:67], v[116:119], v[176:179], v[64:67]
    v_mfma_f32_16x16x32_bf16 v[56:59], v[120:123], v[164:167], v[56:59]
    v_mfma_f32_16x16x32_bf16 v[60:63], v[120:123], v[168:171], v[60:63]
    v_mfma_f32_16x16x32_bf16 v[64:67], v[120:123], v[172:175], v[64:67]
    v_mfma_f32_16x16x32_bf16 v[60:63], v[124:127], v[164:167], v[60:63]
    v_mfma_f32_16x16x32_bf16 v[64:67], v[124:127], v[168:171], v[64:67]
    v_mfma_f32_16x16x32_bf16 v[64:67], v[128:131], v[164:167], v[64:67]
    s_cmp_eq_u32 s39, 5
    s_cbranch_scc1 L_c_dump1
    s_cmp_lg_u32 s56, 8
    s_cbranch_scc1 L_c_loop
L_c_dump1:
    s_nop 7
    ds_write_b128 v29, v[36:39] offset:0
    ds_write_b128 v29, v[40:43] offset:1024
    ds_write_b128 v29, v[44:47] offset:2048
    ds_write_b128 v29, v[48:51] offset:3072
    ds_write_b128 v29, v[52:55] offset:4096
    ds_write_b128 v29, v[56:59] offset:5120
    ds_write_b128 v29, v[60:63] offset:6144
    ds_write_b128 v29, v[64:67] offset:7168
    s_cmp_eq_u32 s39, 5
    s_cbranch_scc1 L_c_convdone
    s_mov_b32 s56, 0
    v_add_u32 v29, 8192, v29
    v_mov_b32 v36, 0
    v_mov_b32 v37, 0
    v_mov_b32 v38, 0
    v_mov_b32 v39, 0
    v_mov_b32 v40, 0
    v_mov_b32 v41, 0
    v_mov_b32 v42, 0
    v_mov_b32 v43, 0
    v_mov_b32 v44, 0
    v_mov_b32 v45, 0
    v_mov_b32 v46, 0
    v_mov_b32 v47, 0
    v_mov_b32 v48, 0
    v_mov_b32 v49, 0
    v_mov_b32 v50, 0
    v_mov_b32 v51, 0
    v_mov_b32 v52, 0
    v_mov_b32 v53, 0
    v_mov_b32 v54, 0
    v_mov_b32 v55, 0
    v_mov_b32 v56, 0
    v_mov_b32 v57, 0
    v_mov_b32 v58, 0
    v_mov_b32 v59, 0
    v_mov_b32 v60, 0
    v_mov_b32 v61, 0
    v_mov_b32 v62, 0
    v_mov_b32 v63, 0
    v_mov_b32 v64, 0
    v_mov_b32 v65, 0
    v_mov_b32 v66, 0
    v_mov_b32 v67, 0
    s_branch L_c_loop
L_c_convdone:
    v_lshlrev_b32 v9, 5, v2
    v_lshl_add_u32 v9, v3, 3, v9
    s_lshl_b32 s30, s25, 9
    v_add_u32 v9, s30, v9
    s_waitcnt lgkmcnt(0)
    ds_read_b64 v[68:69], v9 offset:512
    ds_read_b64 v[70:71], v9 offset:5120
    ds_read_b64 v[72:73], v9 offset:9728
    ds_read_b64 v[74:75], v9 offset:14336
    ds_read_b64 v[76:77], v9 offset:18944
    s_lshl_b32 s30, s25, 10
    s_add_u32 s30, s30, 65536
    v_add_u32 v10, s30, v4
    v_add_u32 v11, 49152, v10
    s_lshl_b32 s31, s24, 12
    s_add_u32 s31, s31, 6291456
    s_waitcnt lgkmcnt(0)
    s_barrier
    ds_read_b128 v[196:199], v10 offset:0
    ds_read_b128 v[200:203], v10 offset:8192
    ds_read_b128 v[204:207], v10 offset:16384
    ds_read_b128 v[208:211], v10 offset:24576
    ds_read_b128 v[212:215], v10 offset:32768
    ds_read_b128 v[216:219], v10 offset:40960
    ds_read_b128 v[220:223], v11 offset:0
    ds_read_b128 v[224:227], v11 offset:8192
    ds_read_b128 v[228:231], v11 offset:16384
    ds_read_b128 v[232:235], v11 offset:24576
    ds_read_b128 v[236:239], v11 offset:32768
    ds_read_b128 v[240:243], v11 offset:40960
    s_lshl_b32 s32, s44, 16
    v_lshlrev_b32 v132, 16, v68
    v_and_b32 v133, s40, v68
    v_lshlrev_b32 v134, 16, v69
    v_and_b32 v135, s40, v69
    v_mul_f32 v132, s32, v132
    v_mul_f32 v133, s32, v133
    v_mul_f32 v134, s32, v134
    v_mul_f32 v135, s32, v135
    v_cvt_pk_bf16_f32 v6, v132, v133
    v_cvt_pk_bf16_f32 v7, v134, v135
    v_lshlrev_b32 v132, 16, v6
    v_and_b32 v133, s40, v6
    v_lshlrev_b32 v134, 16, v7
    v_and_b32 v135, s40, v7
    s_and_b32 s32, s44, s40
    v_lshlrev_b32 v136, 16, v70
    v_and_b32 v137, s40, v70
    v_lshlrev_b32 v138, 16, v71
    v_and_b32 v139, s40, v71
    v_mul_f32 v136, s32, v136
    v_mul_f32 v137, s32, v137
    v_mul_f32 v138, s32, v138
    v_mul_f32 v139, s32, v139
    v_cvt_pk_bf16_f32 v6, v136, v137
    v_cvt_pk_bf16_f32 v7, v138, v139
    v_lshlrev_b32 v136, 16, v6
    v_and_b32 v137, s40, v6
    v_lshlrev_b32 v138, 16, v7
    v_and_b32 v139, s40, v7
    s_lshl_b32 s32, s45, 16
    v_lshlrev_b32 v140, 16, v72
    v_and_b32 v141, s40, v72
    v_lshlrev_b32 v142, 16, v73
    v_and_b32 v143, s40, v73
    v_mul_f32 v140, s32, v140
    v_mul_f32 v141, s32, v141
    v_mul_f32 v142, s32, v142
    v_mul_f32 v143, s32, v143
    v_cvt_pk_bf16_f32 v6, v140, v141
    v_cvt_pk_bf16_f32 v7, v142, v143
    v_lshlrev_b32 v140, 16, v6
    v_and_b32 v141, s40, v6
    v_lshlrev_b32 v142, 16, v7
    v_and_b32 v143, s40, v7
    s_and_b32 s32, s45, s40
    v_lshlrev_b32 v144, 16, v74
    v_and_b32 v145, s40, v74
    v_lshlrev_b32 v146, 16, v75
    v_and_b32 v147, s40, v75
    v_mul_f32 v144, s32, v144
    v_mul_f32 v145, s32, v145
    v_mul_f32 v146, s32, v146
    v_mul_f32 v147, s32, v147
    v_cvt_pk_bf16_f32 v6, v144, v145
    v_cvt_pk_bf16_f32 v7, v146, v147
    v_lshlrev_b32 v144, 16, v6
    v_and_b32 v145, s40, v6
    v_lshlrev_b32 v146, 16, v7
    v_and_b32 v147, s40, v7
    s_lshl_b32 s32, s61, 16
    v_lshlrev_b32 v148, 16, v76
    v_and_b32 v149, s40, v76
    v_lshlrev_b32 v150, 16, v77
    v_and_b32 v151, s40, v77
    v_mul_f32 v148, s32, v148
    v_mul_f32 v149, s32, v149
    v_mul_f32 v150, s32, v150
    v_mul_f32 v151, s32, v151
    v_cvt_pk_bf16_f32 v6, v148, v149
    v_cvt_pk_bf16_f32 v7, v150, v151
    v_lshlrev_b32 v148, 16, v6
    v_and_b32 v149, s40, v6
    v_lshlrev_b32 v150, 16, v7
    v_and_b32 v151, s40, v7
    s_waitcnt lgkmcnt(0)
    v_pk_add_f32 v[196:197], v[196:197], v[200:201]
    v_pk_add_f32 v[198:199], v[198:199], v[202:203]
    v_cvt_pk_bf16_f32 v6, v196, v197
    v_cvt_pk_bf16_f32 v7, v198, v199
    v_lshlrev_b32 v196, 16, v6
    v_and_b32 v197, s40, v6
    v_lshlrev_b32 v198, 16, v7
    v_and_b32 v199, s40, v7
    v_pk_add_f32 v[196:197], v[196:197], v[132:133]
    v_pk_add_f32 v[198:199], v[198:199], v[134:135]
    v_cvt_pk_bf16_f32 v36, v196, v197
    v_cvt_pk_bf16_f32 v37, v198, v199
    buffer_store_dwordx2 v[36:37], v9, s[48:51], s31 offen sc1
    s_add_u32 s31, s31, 4096
    v_pk_add_f32 v[204:205], v[204:205], v[208:209]
    v_pk_add_f32 v[206:207], v[206:207], v[210:211]
    v_pk_add_f32 v[204:205], v[204:205], v[212:213]
    v_pk_add_f32 v[206:207], v[206:207], v[214:215]
    v_cvt_pk_bf16_f32 v6, v204, v205
    v_cvt_pk_bf16_f32 v7, v206, v207
    v_lshlrev_b32 v204, 16, v6
    v_and_b32 v205, s40, v6
    v_lshlrev_b32 v206, 16, v7
    v_and_b32 v207, s40, v7
    v_pk_add_f32 v[204:205], v[204:205], v[136:137]
    v_pk_add_f32 v[206:207], v[206:207], v[138:139]
    v_cvt_pk_bf16_f32 v38, v204, v205
    v_cvt_pk_bf16_f32 v39, v206, v207
    buffer_store_dwordx2 v[38:39], v9, s[48:51], s31 offen sc1
    s_add_u32 s31, s31, 4096
    v_pk_add_f32 v[216:217], v[216:217], v[220:221]
    v_pk_add_f32 v[218:219], v[218:219], v[222:223]
    v_cvt_pk_bf16_f32 v6, v216, v217
    v_cvt_pk_bf16_f32 v7, v218, v219
    v_lshlrev_b32 v216, 16, v6
    v_and_b32 v217, s40, v6
    v_lshlrev_b32 v218, 16, v7
    v_and_b32 v219, s40, v7
    v_pk_add_f32 v[216:217], v[216:217], v[140:141]
    v_pk_add_f32 v[218:219], v[218:219], v[142:143]
    v_cvt_pk_bf16_f32 v40, v216, v217
    v_cvt_pk_bf16_f32 v41, v218, v219
    buffer_store_dwordx2 v[40:41], v9, s[48:51], s31 offen sc1
    s_add_u32 s31, s31, 4096
    v_pk_add_f32 v[224:225], v[224:225], v[228:229]
    v_pk_add_f32 v[226:227], v[226:227], v[230:231]
    v_pk_add_f32 v[224:225], v[224:225], v[232:233]
    v_pk_add_f32 v[226:227], v[226:227], v[234:235]
    v_cvt_pk_bf16_f32 v6, v224, v225
    v_cvt_pk_bf16_f32 v7, v226, v227
    v_lshlrev_b32 v224, 16, v6
    v_and_b32 v225, s40, v6
    v_lshlrev_b32 v226, 16, v7
    v_and_b32 v227, s40, v7
    v_pk_add_f32 v[224:225], v[224:225], v[144:145]
    v_pk_add_f32 v[226:227], v[226:227], v[146:147]
    v_cvt_pk_bf16_f32 v42, v224, v225
    v_cvt_pk_bf16_f32 v43, v226, v227
    buffer_store_dwordx2 v[42:43], v9, s[48:51], s31 offen sc1
    s_add_u32 s31, s31, 4096
    v_pk_add_f32 v[236:237], v[236:237], v[240:241]
    v_pk_add_f32 v[238:239], v[238:239], v[242:243]
    v_cvt_pk_bf16_f32 v6, v236, v237
    v_cvt_pk_bf16_f32 v7, v238, v239
    v_lshlrev_b32 v236, 16, v6
    v_and_b32 v237, s40, v6
    v_lshlrev_b32 v238, 16, v7
    v_and_b32 v239, s40, v7
    v_pk_add_f32 v[236:237], v[236:237], v[148:149]
    v_pk_add_f32 v[238:239], v[238:239], v[150:151]
    v_cvt_pk_bf16_f32 v44, v236, v237
    v_cvt_pk_bf16_f32 v45, v238, v239
    buffer_store_dwordx2 v[44:45], v9, s[48:51], s31 offen sc1
    s_endpgm
L_1_done:
    s_endpgm
.globl attn_out_kernel
.p2align 8
.type attn_out_kernel,@function
attn_out_kernel:
    s_cmp_ge_u32 s2, 256
    s_cbranch_scc1 L_2_done
    s_load_dwordx2 s[4:5], s[0:1], 104
    s_load_dwordx2 s[8:9], s[0:1], 120
    s_and_b32 s22, s2, 7
    s_lshr_b32 s23, s2, 3
    s_lshl_b32 s24, s22, 3
    s_and_b32 s28, s23, 7
    s_add_u32 s24, s24, s28
    s_lshr_b32 s25, s23, 3
    v_lshrrev_b32 v6, 6, v0
    v_and_b32 v1, 63, v0
    v_readfirstlane_b32 s26, v6
    v_and_b32 v2, 15, v0
    v_lshrrev_b32 v3, 4, v1
    v_lshlrev_b32 v4, 4, v1
    s_mov_b32 s36, 0xffff0000
    s_mov_b32 s37, 0x358637bd
    s_and_b32 s27, s26, 3
    s_lshr_b32 s38, s26, 2
    s_lshl_b32 s28, s24, 1
    s_add_u32 s28, s28, s38
    s_lshl_b32 s28, s28, 3
    s_lshl_b32 s29, s27, 1
    s_add_u32 s28, s28, s29
    s_mul_i32 s28, s28, 3072
    s_add_u32 s28, s28, 2097152
    s_add_u32 s29, s28, 4096
    s_mul_i32 s30, s26, 10240
    s_mul_i32 s39, s25, 200
    s_mul_i32 s31, s38, 100
    s_add_u32 s39, s39, s31
    s_mul_i32 s31, s27, 5
    s_add_u32 s39, s39, s31
    s_lshl_b32 s39, s39, 10
    s_add_u32 s39, s39, 262144
    s_waitcnt lgkmcnt(0)
    s_and_b32 s5, s5, 0xffff
    s_mov_b32 s6, 2621440
    s_mov_b32 s7, 0x00020000
    s_and_b32 s9, s9, 0xffff
    s_mov_b32 s10, 13631488
    s_mov_b32 s11, 0x00020000
    s_add_u32 m0, s30, 0
    s_add_u32 s31, s30, 0
    buffer_load_dwordx4 v4, s[8:11], s31 offen offset:0 lds
    buffer_load_dwordx4 v4, s[8:11], s31 offen offset:1024 lds
    buffer_load_dwordx4 v4, s[8:11], s31 offen offset:2048 lds
    buffer_load_dwordx4 v4, s[8:11], s31 offen offset:3072 lds
    s_add_u32 m0, s30, 4096
    s_add_u32 s31, s30, 4096
    buffer_load_dwordx4 v4, s[8:11], s31 offen offset:0 lds
    buffer_load_dwordx4 v4, s[8:11], s31 offen offset:1024 lds
    buffer_load_dwordx4 v4, s[8:11], s31 offen offset:2048 lds
    buffer_load_dwordx4 v4, s[8:11], s31 offen offset:3072 lds
    s_add_u32 m0, s30, 8192
    s_add_u32 s31, s30, 8192
    buffer_load_dwordx4 v4, s[8:11], s31 offen offset:0 lds
    buffer_load_dwordx4 v4, s[8:11], s31 offen offset:1024 lds
    buffer_load_dwordx4 v[28:31], v4, s[8:11], s28 offen offset:0
    buffer_load_dwordx4 v[32:35], v4, s[8:11], s28 offen offset:1024
    buffer_load_dwordx4 v[36:39], v4, s[8:11], s28 offen offset:2048
    buffer_load_dwordx4 v[40:43], v4, s[8:11], s28 offen offset:3072
    buffer_load_dwordx4 v[44:47], v4, s[8:11], s29 offen offset:0
    buffer_load_dwordx4 v[48:51], v4, s[8:11], s29 offen offset:1024
    v_lshlrev_b32 v6, 3, v3
    v_and_b32 v7, 3, v2
    v_cmp_eq_u32 s[32:33], 0, v7
    v_lshrrev_b32 v7, 2, v2
    s_mul_i32 s30, s27, 20480
    v_add_u32 v8, 8, v7
    v_cndmask_b32 v8, 0, v8, s[32:33]
    s_mov_b32 s28, 0xf020100
    v_bfe_u32 v9, s28, v6, 8
    v_cmp_gt_u32 vcc, 4, v9
    v_lshlrev_b32 v10, 8, v9
    v_add_u32 v11, 0, v10
    v_mov_b32 v12, 2048
    v_cndmask_b32 v11, v12, v11, vcc
    v_lshl_add_u32 v11, v2, 4, v11
    v_add_u32 v148, s30, v11
    v_add_u32 v11, 3072, v10
    v_mov_b32 v12, 4096
    v_cndmask_b32 v11, v12, v11, vcc
    v_lshl_add_u32 v11, v8, 4, v11
    v_add_u32 v150, s30, v11
    s_mov_b32 s28, 0xf0f0403
    v_bfe_u32 v9, s28, v6, 8
    v_cmp_gt_u32 vcc, 4, v9
    v_lshlrev_b32 v10, 8, v9
    v_add_u32 v11, 0, v10
    v_mov_b32 v12, 2048
    v_cndmask_b32 v11, v12, v11, vcc
    v_lshl_add_u32 v11, v2, 4, v11
    v_add_u32 v149, s30, v11
    v_add_u32 v11, 3072, v10
    v_mov_b32 v12, 4096
    v_cndmask_b32 v11, v12, v11, vcc
    v_lshl_add_u32 v11, v8, 4, v11
    v_add_u32 v151, s30, v11
    v_add_u32 v8, 12, v7
    v_cndmask_b32 v8, 1, v8, s[32:33]
    s_mov_b32 s28, 0x1000f0f
    v_bfe_u32 v9, s28, v6, 8
    v_cmp_gt_u32 vcc, 4, v9
    v_lshlrev_b32 v10, 8, v9
    v_add_u32 v11, 1024, v10
    v_mov_b32 v12, 2304
    v_cndmask_b32 v11, v12, v11, vcc
    v_lshl_add_u32 v11, v2, 4, v11
    v_add_u32 v152, s30, v11
    v_add_u32 v11, 3072, v10
    v_mov_b32 v12, 4352
    v_cndmask_b32 v11, v12, v11, vcc
    v_lshl_add_u32 v11, v8, 4, v11
    v_add_u32 v154, s30, v11
    s_mov_b32 s28, 0x403020f
    v_bfe_u32 v9, s28, v6, 8
    v_cmp_gt_u32 vcc, 4, v9
    v_lshlrev_b32 v10, 8, v9
    v_add_u32 v11, 1024, v10
    v_mov_b32 v12, 2304
    v_cndmask_b32 v11, v12, v11, vcc
    v_lshl_add_u32 v11, v2, 4, v11
    v_add_u32 v153, s30, v11
    v_add_u32 v11, 3072, v10
    v_mov_b32 v12, 4352
    v_cndmask_b32 v11, v12, v11, vcc
    v_lshl_add_u32 v11, v8, 4, v11
    v_add_u32 v155, s30, v11
    s_add_u32 s28, s39, 0
    buffer_load_dwordx4 v[196:199], v4, s[8:11], s28 offen offset:0
    s_add_u32 s28, s28, 20480
    buffer_load_dwordx4 v[200:203], v4, s[8:11], s28 offen offset:0
    s_add_u32 s28, s28, 20480
    buffer_load_dwordx4 v[204:207], v4, s[8:11], s28 offen offset:0
    s_add_u32 s28, s28, 20480
    buffer_load_dwordx4 v[208:211], v4, s[8:11], s28 offen offset:0
    s_add_u32 s28, s28, 20480
    buffer_load_dwordx4 v[212:215], v4, s[8:11], s28 offen offset:0
    s_lshl_b32 s28, s24, 7
    s_add_u32 s28, s28, 131072
    v_lshlrev_b32 v6, 2, v2
    buffer_load_dword v26, v6, s[8:11], s28 offen
    buffer_load_dword v27, v6, s[8:11], s28 offen offset:64
    s_mul_i32 s29, s25, 655360
    s_lshl_b32 s30, s24, 6
    s_add_u32 s29, s29, s30
    s_lshl_b32 s30, s26, 16
    s_add_u32 s29, s29, s30
    s_add_u32 s29, s29, 6291456
    v_lshrrev_b32 v8, 2, v1
    v_lshlrev_b32 v8, 12, v8
    v_and_b32 v9, 3, v1
    v_lshl_add_u32 v8, v9, 4, v8
    s_lshl_b32 s30, s26, 10
    s_add_u32 m0, s30, 122880
    s_nop 0
    buffer_load_dwordx4 v8, s[8:11], s29 offen lds
    s_add_u32 m0, s30, 131072
    s_add_u32 s29, s29, 524288
    s_cmp_lt_u32 s26, 2
    s_cselect_b32 s29, s29, 0x40000000
    buffer_load_dwordx4 v8, s[8:11], s29 offen lds
    v_mov_b32 v52, 0
    v_mov_b32 v53, 0
    v_mov_b32 v54, 0
    v_mov_b32 v55, 0
    v_mov_b32 v56, 0
    v_mov_b32 v57, 0
    v_mov_b32 v58, 0
    v_mov_b32 v59, 0
    v_mov_b32 v60, 0
    v_mov_b32 v61, 0
    v_mov_b32 v62, 0
    v_mov_b32 v63, 0
    v_mov_b32 v64, 0
    v_mov_b32 v65, 0
    v_mov_b32 v66, 0
    v_mov_b32 v67, 0
    v_mov_b32 v68, 0
    v_mov_b32 v69, 0
    v_mov_b32 v70, 0
    v_mov_b32 v71, 0
    v_mov_b32 v72, 0
    v_mov_b32 v73, 0
    v_mov_b32 v74, 0
    v_mov_b32 v75, 0
    v_mov_b32 v76, 0
    v_mov_b32 v77, 0
    v_mov_b32 v78, 0
    v_mov_b32 v79, 0
    v_mov_b32 v80, 0
    v_mov_b32 v81, 0
    v_mov_b32 v82, 0
    v_mov_b32 v83, 0
    v_mov_b32 v84, 0
    v_mov_b32 v85, 0
    v_mov_b32 v86, 0
    v_mov_b32 v87, 0
    v_mov_b32 v88, 0
    v_mov_b32 v89, 0
    v_mov_b32 v90, 0
    v_mov_b32 v91, 0
    v_mov_b32 v92, 0
    v_mov_b32 v93, 0
    v_mov_b32 v94, 0
    v_mov_b32 v95, 0
    v_mov_b32 v96, 0
    v_mov_b32 v97, 0
    v_mov_b32 v98, 0
    v_mov_b32 v99, 0
    v_mov_b32 v100, 0
    v_mov_b32 v101, 0
    v_mov_b32 v102, 0
    v_mov_b32 v103, 0
    v_mov_b32 v104, 0
    v_mov_b32 v105, 0
    v_mov_b32 v106, 0
    v_mov_b32 v107, 0
    v_mov_b32 v108, 0
    v_mov_b32 v109, 0
    v_mov_b32 v110, 0
    v_mov_b32 v111, 0
    v_mov_b32 v112, 0
    v_mov_b32 v113, 0
    v_mov_b32 v114, 0
    v_mov_b32 v115, 0
    s_mov_b32 s44, 0xffffffff
    s_mov_b32 s45, 0xffff
    s_mov_b32 s46, 0xffffffff
    s_mov_b32 s47, 0x0
    s_mov_b32 s48, 0x0
    s_mov_b32 s49, 0xffffffff
    s_mov_b32 s50, 0xffff0000
    s_mov_b32 s51, 0xffffffff
    s_waitcnt vmcnt(9)
    s_barrier
    s_mov_b64 exec, s[44:45]
    ds_read_b128 v[52:55], v148 offset:0
    ds_read_b128 v[60:63], v150 offset:0
    s_mov_b64 exec, s[46:47]
    ds_read_b128 v[56:59], v149 offset:0
    ds_read_b128 v[64:67], v151 offset:0
    s_mov_b64 exec, s[48:49]
    ds_read_b128 v[68:71], v152 offset:0
    ds_read_b128 v[76:79], v154 offset:0
    s_mov_b64 exec, s[50:51]
    ds_read_b128 v[72:75], v153 offset:0
    ds_read_b128 v[80:83], v155 offset:0
    s_mov_b64 exec, -1
    s_mov_b64 exec, s[44:45]
    ds_read_b128 v[84:87], v148 offset:5120
    ds_read_b128 v[92:95], v150 offset:5120
    s_mov_b64 exec, s[46:47]
    ds_read_b128 v[88:91], v149 offset:5120
    ds_read_b128 v[96:99], v151 offset:5120
    s_mov_b64 exec, s[48:49]
    ds_read_b128 v[100:103], v152 offset:5120
    ds_read_b128 v[108:111], v154 offset:5120
    s_mov_b64 exec, s[50:51]
    ds_read_b128 v[104:107], v153 offset:5120
    ds_read_b128 v[112:115], v155 offset:5120
    s_mov_b64 exec, -1
    s_add_u32 s28, s39, 0
    buffer_load_dwordx4 v[216:219], v4, s[8:11], s28 offen offset:1024
    s_add_u32 s28, s28, 20480
    buffer_load_dwordx4 v[220:223], v4, s[8:11], s28 offen offset:1024
    s_add_u32 s28, s28, 20480
    buffer_load_dwordx4 v[224:227], v4, s[8:11], s28 offen offset:1024
    s_add_u32 s28, s28, 20480
    buffer_load_dwordx4 v[228:231], v4, s[8:11], s28 offen offset:1024
    s_add_u32 s28, s28, 20480
    buffer_load_dwordx4 v[232:235], v4, s[8:11], s28 offen offset:1024
    s_waitcnt lgkmcnt(8)
    v_cvt_pk_bf16_f32 v116, v52, v53
    v_cvt_pk_bf16_f32 v117, v54, v55
    v_cvt_pk_bf16_f32 v118, v56, v57
    v_cvt_pk_bf16_f32 v119, v58, v59
    v_cvt_pk_bf16_f32 v120, v60, v61
    v_cvt_pk_bf16_f32 v121, v62, v63
    v_cvt_pk_bf16_f32 v122, v64, v65
    v_cvt_pk_bf16_f32 v123, v66, v67
    v_cvt_pk_bf16_f32 v124, v68, v69
    v_cvt_pk_bf16_f32 v125, v70, v71
    v_cvt_pk_bf16_f32 v126, v72, v73
    v_cvt_pk_bf16_f32 v127, v74, v75
    v_cvt_pk_bf16_f32 v128, v76, v77
    v_cvt_pk_bf16_f32 v129, v78, v79
    v_cvt_pk_bf16_f32 v130, v80, v81
    v_cvt_pk_bf16_f32 v131, v82, v83
    s_mov_b64 exec, s[44:45]
    ds_read_b128 v[52:55], v148 offset:10240
    ds_read_b128 v[60:63], v150 offset:10240
    s_mov_b64 exec, s[46:47]
    ds_read_b128 v[56:59], v149 offset:10240
    ds_read_b128 v[64:67], v151 offset:10240
    s_mov_b64 exec, s[48:49]
    ds_read_b128 v[68:71], v152 offset:10240
    ds_read_b128 v[76:79], v154 offset:10240
    s_mov_b64 exec, s[50:51]
    ds_read_b128 v[72:75], v153 offset:10240
    ds_read_b128 v[80:83], v155 offset:10240
    s_mov_b64 exec, -1
    v_mfma_f32_16x16x32_bf16 v[132:135], v[116:119], v[28:31], 0
    v_mfma_f32_16x16x32_bf16 v[136:139], v[120:123], v[28:31], 0
    v_mfma_f32_16x16x32_bf16 v[140:143], v[124:127], v[30:33], 0
    v_mfma_f32_16x16x32_bf16 v[144:147], v[128:131], v[30:33], 0
    s_add_u32 s28, s39, 0
    buffer_load_dwordx4 v[236:239], v4, s[8:11], s28 offen offset:2048
    s_add_u32 s28, s28, 20480
    buffer_load_dwordx4 v[240:243], v4, s[8:11], s28 offen offset:2048
    s_add_u32 s28, s28, 20480
    buffer_load_dwordx4 v[244:247], v4, s[8:11], s28 offen offset:2048
    s_add_u32 s28, s28, 20480
    buffer_load_dwordx4 v[248:251], v4, s[8:11], s28 offen offset:2048
    s_add_u32 s28, s28, 20480
    buffer_load_dwordx4 v[252:255], v4, s[8:11], s28 offen offset:2048
    v_cvt_pk_bf16_f32 v6, v136, v137
    v_cvt_pk_bf16_f32 v7, v132, v133
    v_cvt_pk_bf16_f32 v8, v134, v135
    v_and_b32 v9, s36, v6
    v_add_f32 v9, s37, v9
    v_cvt_pk_bf16_f32 v9, v9, v9
    v_lshlrev_b32 v9, 16, v9
    v_rcp_f32 v9, v9
    v_lshlrev_b32 v16, 16, v7
    v_and_b32 v17, s36, v7
    v_lshlrev_b32 v18, 16, v8
    v_and_b32 v19, s36, v8
    v_lshlrev_b32 v20, 16, v6
    v_mul_f32 v16, v16, v9
    v_mul_f32 v17, v17, v9
    v_mul_f32 v18, v18, v9
    v_mul_f32 v19, v19, v9
    v_mul_f32 v20, v20, v9
    v_cvt_pk_bf16_f32 v10, v144, v145
    v_cvt_pk_bf16_f32 v11, v140, v141
    v_cvt_pk_bf16_f32 v12, v142, v143
    v_and_b32 v13, s36, v10
    v_add_f32 v13, s37, v13
    v_cvt_pk_bf16_f32 v13, v13, v13
    v_lshlrev_b32 v13, 16, v13
    v_rcp_f32 v13, v13
    v_lshlrev_b32 v21, 16, v11
    v_and_b32 v22, s36, v11
    v_lshlrev_b32 v23, 16, v12
    v_and_b32 v24, s36, v12
    v_lshlrev_b32 v25, 16, v10
    v_mul_f32 v21, v21, v13
    v_mul_f32 v22, v22, v13
    v_mul_f32 v23, v23, v13
    v_mul_f32 v24, v24, v13
    v_mul_f32 v25, v25, v13
    v_cvt_pk_bf16_f32 v156, v16, v17
    v_cvt_pk_bf16_f32 v157, v18, v19
    v_cvt_pk_bf16_f32 v158, v20, v21
    v_cvt_pk_bf16_f32 v159, v22, v23
    v_cvt_pk_bf16_f32 v160, v24, v25
    s_waitcnt lgkmcnt(8)
    v_cvt_pk_bf16_f32 v116, v84, v85
    v_cvt_pk_bf16_f32 v117, v86, v87
    v_cvt_pk_bf16_f32 v118, v88, v89
    v_cvt_pk_bf16_f32 v119, v90, v91
    v_cvt_pk_bf16_f32 v120, v92, v93
    v_cvt_pk_bf16_f32 v121, v94, v95
    v_cvt_pk_bf16_f32 v122, v96, v97
    v_cvt_pk_bf16_f32 v123, v98, v99
    v_cvt_pk_bf16_f32 v124, v100, v101
    v_cvt_pk_bf16_f32 v125, v102, v103
    v_cvt_pk_bf16_f32 v126, v104, v105
    v_cvt_pk_bf16_f32 v127, v106, v107
    v_cvt_pk_bf16_f32 v128, v108, v109
    v_cvt_pk_bf16_f32 v129, v110, v111
    v_cvt_pk_bf16_f32 v130, v112, v113
    v_cvt_pk_bf16_f32 v131, v114, v115
    s_mov_b64 exec, s[44:45]
    ds_read_b128 v[84:87], v148 offset:15360
    ds_read_b128 v[92:95], v150 offset:15360
    s_mov_b64 exec, s[46:47]
    ds_read_b128 v[88:91], v149 offset:15360
    ds_read_b128 v[96:99], v151 offset:15360
    s_mov_b64 exec, s[48:49]
    ds_read_b128 v[100:103], v152 offset:15360
    ds_read_b128 v[108:111], v154 offset:15360
    s_mov_b64 exec, s[50:51]
    ds_read_b128 v[104:107], v153 offset:15360
    ds_read_b128 v[112:115], v155 offset:15360
    s_mov_b64 exec, -1
    v_mfma_f32_16x16x32_bf16 v[132:135], v[116:119], v[34:37], 0
    v_mfma_f32_16x16x32_bf16 v[136:139], v[120:123], v[34:37], 0
    v_mfma_f32_16x16x32_bf16 v[140:143], v[124:127], v[36:39], 0
    v_mfma_f32_16x16x32_bf16 v[144:147], v[128:131], v[36:39], 0
    s_nop 7
    v_cvt_pk_bf16_f32 v6, v136, v137
    v_cvt_pk_bf16_f32 v7, v132, v133
    v_cvt_pk_bf16_f32 v8, v134, v135
    v_and_b32 v9, s36, v6
    v_add_f32 v9, s37, v9
    v_cvt_pk_bf16_f32 v9, v9, v9
    v_lshlrev_b32 v9, 16, v9
    v_rcp_f32 v9, v9
    v_lshlrev_b32 v16, 16, v7
    v_and_b32 v17, s36, v7
    v_lshlrev_b32 v18, 16, v8
    v_and_b32 v19, s36, v8
    v_lshlrev_b32 v20, 16, v6
    v_mul_f32 v16, v16, v9
    v_mul_f32 v17, v17, v9
    v_mul_f32 v18, v18, v9
    v_mul_f32 v19, v19, v9
    v_mul_f32 v20, v20, v9
    v_cvt_pk_bf16_f32 v10, v144, v145
    v_cvt_pk_bf16_f32 v11, v140, v141
    v_cvt_pk_bf16_f32 v12, v142, v143
    v_and_b32 v13, s36, v10
    v_add_f32 v13, s37, v13
    v_cvt_pk_bf16_f32 v13, v13, v13
    v_lshlrev_b32 v13, 16, v13
    v_rcp_f32 v13, v13
    v_lshlrev_b32 v21, 16, v11
    v_and_b32 v22, s36, v11
    v_lshlrev_b32 v23, 16, v12
    v_and_b32 v24, s36, v12
    v_lshlrev_b32 v25, 16, v10
    v_mul_f32 v21, v21, v13
    v_mul_f32 v22, v22, v13
    v_mul_f32 v23, v23, v13
    v_mul_f32 v24, v24, v13
    v_mul_f32 v25, v25, v13
    v_cvt_pk_bf16_f32 v161, v16, v17
    v_cvt_pk_bf16_f32 v162, v18, v19
    v_cvt_pk_bf16_f32 v163, v20, v21
    v_cvt_pk_bf16_f32 v164, v22, v23
    v_cvt_pk_bf16_f32 v165, v24, v25
    s_waitcnt lgkmcnt(8)
    v_cvt_pk_bf16_f32 v116, v52, v53
    v_cvt_pk_bf16_f32 v117, v54, v55
    v_cvt_pk_bf16_f32 v118, v56, v57
    v_cvt_pk_bf16_f32 v119, v58, v59
    v_cvt_pk_bf16_f32 v120, v60, v61
    v_cvt_pk_bf16_f32 v121, v62, v63
    v_cvt_pk_bf16_f32 v122, v64, v65
    v_cvt_pk_bf16_f32 v123, v66, v67
    v_cvt_pk_bf16_f32 v124, v68, v69
    v_cvt_pk_bf16_f32 v125, v70, v71
    v_cvt_pk_bf16_f32 v126, v72, v73
    v_cvt_pk_bf16_f32 v127, v74, v75
    v_cvt_pk_bf16_f32 v128, v76, v77
    v_cvt_pk_bf16_f32 v129, v78, v79
    v_cvt_pk_bf16_f32 v130, v80, v81
    v_cvt_pk_bf16_f32 v131, v82, v83
    s_nop 1
    v_mfma_f32_16x16x32_bf16 v[132:135], v[116:119], v[40:43], 0
    v_mfma_f32_16x16x32_bf16 v[136:139], v[120:123], v[40:43], 0
    v_mfma_f32_16x16x32_bf16 v[140:143], v[124:127], v[42:45], 0
    v_mfma_f32_16x16x32_bf16 v[144:147], v[128:131], v[42:45], 0
    s_nop 7
    v_cvt_pk_bf16_f32 v6, v136, v137
    v_cvt_pk_bf16_f32 v7, v132, v133
    v_cvt_pk_bf16_f32 v8, v134, v135
    v_and_b32 v9, s36, v6
    v_add_f32 v9, s37, v9
    v_cvt_pk_bf16_f32 v9, v9, v9
    v_lshlrev_b32 v9, 16, v9
    v_rcp_f32 v9, v9
    v_lshlrev_b32 v16, 16, v7
    v_and_b32 v17, s36, v7
    v_lshlrev_b32 v18, 16, v8
    v_and_b32 v19, s36, v8
    v_lshlrev_b32 v20, 16, v6
    v_mul_f32 v16, v16, v9
    v_mul_f32 v17, v17, v9
    v_mul_f32 v18, v18, v9
    v_mul_f32 v19, v19, v9
    v_mul_f32 v20, v20, v9
    v_cvt_pk_bf16_f32 v10, v144, v145
    v_cvt_pk_bf16_f32 v11, v140, v141
    v_cvt_pk_bf16_f32 v12, v142, v143
    v_and_b32 v13, s36, v10
    v_add_f32 v13, s37, v13
    v_cvt_pk_bf16_f32 v13, v13, v13
    v_lshlrev_b32 v13, 16, v13
    v_rcp_f32 v13, v13
    v_lshlrev_b32 v21, 16, v11
    v_and_b32 v22, s36, v11
    v_lshlrev_b32 v23, 16, v12
    v_and_b32 v24, s36, v12
    v_lshlrev_b32 v25, 16, v10
    v_mul_f32 v21, v21, v13
    v_mul_f32 v22, v22, v13
    v_mul_f32 v23, v23, v13
    v_mul_f32 v24, v24, v13
    v_mul_f32 v25, v25, v13
    v_cvt_pk_bf16_f32 v166, v16, v17
    v_cvt_pk_bf16_f32 v167, v18, v19
    v_cvt_pk_bf16_f32 v168, v20, v21
    v_cvt_pk_bf16_f32 v169, v22, v23
    v_cvt_pk_bf16_f32 v170, v24, v25
    s_waitcnt lgkmcnt(0)
    v_cvt_pk_bf16_f32 v116, v84, v85
    v_cvt_pk_bf16_f32 v117, v86, v87
    v_cvt_pk_bf16_f32 v118, v88, v89
    v_cvt_pk_bf16_f32 v119, v90, v91
    v_cvt_pk_bf16_f32 v120, v92, v93
    v_cvt_pk_bf16_f32 v121, v94, v95
    v_cvt_pk_bf16_f32 v122, v96, v97
    v_cvt_pk_bf16_f32 v123, v98, v99
    v_cvt_pk_bf16_f32 v124, v100, v101
    v_cvt_pk_bf16_f32 v125, v102, v103
    v_cvt_pk_bf16_f32 v126, v104, v105
    v_cvt_pk_bf16_f32 v127, v106, v107
    v_cvt_pk_bf16_f32 v128, v108, v109
    v_cvt_pk_bf16_f32 v129, v110, v111
    v_cvt_pk_bf16_f32 v130, v112, v113
    v_cvt_pk_bf16_f32 v131, v114, v115
    s_nop 1
    v_mfma_f32_16x16x32_bf16 v[132:135], v[116:119], v[46:49], 0
    v_mfma_f32_16x16x32_bf16 v[136:139], v[120:123], v[46:49], 0
    v_mfma_f32_16x16x32_bf16 v[140:143], v[124:127], v[48:51], 0
    v_mfma_f32_16x16x32_bf16 v[144:147], v[128:131], v[48:51], 0
    s_nop 7
    s_add_u32 s28, s39, 0
    buffer_load_dwordx4 v[28:31], v4, s[8:11], s28 offen offset:3072
    s_add_u32 s28, s28, 20480
    buffer_load_dwordx4 v[32:35], v4, s[8:11], s28 offen offset:3072
    s_add_u32 s28, s28, 20480
    buffer_load_dwordx4 v[36:39], v4, s[8:11], s28 offen offset:3072
    s_add_u32 s28, s28, 20480
    buffer_load_dwordx4 v[40:43], v4, s[8:11], s28 offen offset:3072
    s_add_u32 s28, s28, 20480
    buffer_load_dwordx4 v[44:47], v4, s[8:11], s28 offen offset:3072
    v_cvt_pk_bf16_f32 v6, v136, v137
    v_cvt_pk_bf16_f32 v7, v132, v133
    v_cvt_pk_bf16_f32 v8, v134, v135
    v_and_b32 v9, s36, v6
    v_add_f32 v9, s37, v9
    v_cvt_pk_bf16_f32 v9, v9, v9
    v_lshlrev_b32 v9, 16, v9
    v_rcp_f32 v9, v9
    v_lshlrev_b32 v16, 16, v7
    v_and_b32 v17, s36, v7
    v_lshlrev_b32 v18, 16, v8
    v_and_b32 v19, s36, v8
    v_lshlrev_b32 v20, 16, v6
    v_mul_f32 v16, v16, v9
    v_mul_f32 v17, v17, v9
    v_mul_f32 v18, v18, v9
    v_mul_f32 v19, v19, v9
    v_mul_f32 v20, v20, v9
    v_cvt_pk_bf16_f32 v10, v144, v145
    v_cvt_pk_bf16_f32 v11, v140, v141
    v_cvt_pk_bf16_f32 v12, v142, v143
    v_and_b32 v13, s36, v10
    v_add_f32 v13, s37, v13
    v_cvt_pk_bf16_f32 v13, v13, v13
    v_lshlrev_b32 v13, 16, v13
    v_rcp_f32 v13, v13
    v_lshlrev_b32 v21, 16, v11
    v_and_b32 v22, s36, v11
    v_lshlrev_b32 v23, 16, v12
    v_and_b32 v24, s36, v12
    v_lshlrev_b32 v25, 16, v10
    v_mul_f32 v21, v21, v13
    v_mul_f32 v22, v22, v13
    v_mul_f32 v23, v23, v13
    v_mul_f32 v24, v24, v13
    v_mul_f32 v25, v25, v13
    v_cvt_pk_bf16_f32 v171, v16, v17
    v_cvt_pk_bf16_f32 v172, v18, v19
    v_cvt_pk_bf16_f32 v173, v20, v21
    v_cvt_pk_bf16_f32 v174, v22, v23
    v_cvt_pk_bf16_f32 v175, v24, v25
    s_add_u32 s28, s39, 4096
    buffer_load_dwordx4 v[116:119], v4, s[8:11], s28 offen offset:0
    s_add_u32 s28, s28, 20480
    buffer_load_dwordx4 v[120:123], v4, s[8:11], s28 offen offset:0
    s_add_u32 s28, s28, 20480
    buffer_load_dwordx4 v[124:127], v4, s[8:11], s28 offen offset:0
    s_add_u32 s28, s28, 20480
    buffer_load_dwordx4 v[128:131], v4, s[8:11], s28 offen offset:0
    s_add_u32 s28, s28, 20480
    buffer_load_dwordx4 v[132:135], v4, s[8:11], s28 offen offset:0
    s_mul_i32 s28, s26, 5120
    s_add_u32 s28, s28, 81920
    v_add_u32 v6, s28, v4
    s_xor_b32 s29, s26, 4
    s_mul_i32 s29, s29, 5120
    s_add_u32 s29, s29, 81920
    v_add_u32 v7, s29, v4
    ds_write_b128 v6, v[156:159] offset:0
    ds_write_b128 v6, v[160:163] offset:1024
    ds_write_b128 v6, v[164:167] offset:2048
    ds_write_b128 v6, v[168:171] offset:3072
    ds_write_b128 v6, v[172:175] offset:4096
    s_waitcnt vmcnt(10) lgkmcnt(0)
    s_barrier
    ds_read_b128 v[176:179], v7 offset:0
    ds_read_b128 v[180:183], v7 offset:1024
    ds_read_b128 v[184:187], v7 offset:2048
    ds_read_b128 v[188:191], v7 offset:3072
    ds_read_b128 v[192:195], v7 offset:4096
    v_mfma_f32_16x16x32_bf16 v[52:55], v[196:199], v[156:159], 0
    v_mfma_f32_16x16x32_bf16 v[56:59], v[200:203], v[156:159], 0
    v_mfma_f32_16x16x32_bf16 v[60:63], v[204:207], v[156:159], 0
    v_mfma_f32_16x16x32_bf16 v[64:67], v[208:211], v[156:159], 0
    v_mfma_f32_16x16x32_bf16 v[68:71], v[212:215], v[156:159], 0
    v_mfma_f32_16x16x32_bf16 v[52:55], v[216:219], v[160:163], v[52:55]
    v_mfma_f32_16x16x32_bf16 v[56:59], v[220:223], v[160:163], v[56:59]
    v_mfma_f32_16x16x32_bf16 v[60:63], v[224:227], v[160:163], v[60:63]
    v_mfma_f32_16x16x32_bf16 v[64:67], v[228:231], v[160:163], v[64:67]
    v_mfma_f32_16x16x32_bf16 v[68:71], v[232:235], v[160:163], v[68:71]
    v_mfma_f32_16x16x32_bf16 v[52:55], v[236:239], v[164:167], v[52:55]
    v_mfma_f32_16x16x32_bf16 v[56:59], v[240:243], v[164:167], v[56:59]
    v_mfma_f32_16x16x32_bf16 v[60:63], v[244:247], v[164:167], v[60:63]
    v_mfma_f32_16x16x32_bf16 v[64:67], v[248:251], v[164:167], v[64:67]
    v_mfma_f32_16x16x32_bf16 v[68:71], v[252:255], v[164:167], v[68:71]
    s_waitcnt lgkmcnt(0)
    v_mfma_f32_16x16x32_bf16 v[72:75], v[196:199], v[176:179], 0
    v_mfma_f32_16x16x32_bf16 v[76:79], v[200:203], v[176:179], 0
    v_mfma_f32_16x16x32_bf16 v[80:83], v[204:207], v[176:179], 0
    v_mfma_f32_16x16x32_bf16 v[84:87], v[208:211], v[176:179], 0
    v_mfma_f32_16x16x32_bf16 v[88:91], v[212:215], v[176:179], 0
    v_mfma_f32_16x16x32_bf16 v[72:75], v[216:219], v[180:183], v[72:75]
    v_mfma_f32_16x16x32_bf16 v[76:79], v[220:223], v[180:183], v[76:79]
    v_mfma_f32_16x16x32_bf16 v[80:83], v[224:227], v[180:183], v[80:83]
    v_mfma_f32_16x16x32_bf16 v[84:87], v[228:231], v[180:183], v[84:87]
    v_mfma_f32_16x16x32_bf16 v[88:91], v[232:235], v[180:183], v[88:91]
    v_mfma_f32_16x16x32_bf16 v[72:75], v[236:239], v[184:187], v[72:75]
    v_mfma_f32_16x16x32_bf16 v[76:79], v[240:243], v[184:187], v[76:79]
    v_mfma_f32_16x16x32_bf16 v[80:83], v[244:247], v[184:187], v[80:83]
    v_mfma_f32_16x16x32_bf16 v[84:87], v[248:251], v[184:187], v[84:87]
    v_mfma_f32_16x16x32_bf16 v[88:91], v[252:255], v[184:187], v[88:91]
    s_waitcnt vmcnt(5)
    v_mfma_f32_16x16x32_bf16 v[52:55], v[28:31], v[168:171], v[52:55]
    v_mfma_f32_16x16x32_bf16 v[56:59], v[32:35], v[168:171], v[56:59]
    v_mfma_f32_16x16x32_bf16 v[60:63], v[36:39], v[168:171], v[60:63]
    v_mfma_f32_16x16x32_bf16 v[64:67], v[40:43], v[168:171], v[64:67]
    v_mfma_f32_16x16x32_bf16 v[68:71], v[44:47], v[168:171], v[68:71]
    v_mfma_f32_16x16x32_bf16 v[72:75], v[28:31], v[188:191], v[72:75]
    v_mfma_f32_16x16x32_bf16 v[76:79], v[32:35], v[188:191], v[76:79]
    v_mfma_f32_16x16x32_bf16 v[80:83], v[36:39], v[188:191], v[80:83]
    v_mfma_f32_16x16x32_bf16 v[84:87], v[40:43], v[188:191], v[84:87]
    v_mfma_f32_16x16x32_bf16 v[88:91], v[44:47], v[188:191], v[88:91]
    s_waitcnt vmcnt(0)
    v_mfma_f32_16x16x32_bf16 v[52:55], v[116:119], v[172:175], v[52:55]
    v_mfma_f32_16x16x32_bf16 v[56:59], v[120:123], v[172:175], v[56:59]
    v_mfma_f32_16x16x32_bf16 v[60:63], v[124:127], v[172:175], v[60:63]
    v_mfma_f32_16x16x32_bf16 v[64:67], v[128:131], v[172:175], v[64:67]
    v_mfma_f32_16x16x32_bf16 v[68:71], v[132:135], v[172:175], v[68:71]
    v_mfma_f32_16x16x32_bf16 v[72:75], v[116:119], v[192:195], v[72:75]
    v_mfma_f32_16x16x32_bf16 v[76:79], v[120:123], v[192:195], v[76:79]
    v_mfma_f32_16x16x32_bf16 v[80:83], v[124:127], v[192:195], v[80:83]
    v_mfma_f32_16x16x32_bf16 v[84:87], v[128:131], v[192:195], v[84:87]
    v_mfma_f32_16x16x32_bf16 v[88:91], v[132:135], v[192:195], v[88:91]
    s_mul_i32 s28, s38, 40960
    s_lshl_b32 s29, s27, 10
    s_add_u32 s28, s28, s29
    s_lshl_b32 s29, s38, 12
    s_add_u32 s30, s28, s29
    v_add_u32 v6, s30, v4
    s_xor_b32 s29, s29, 4096
    s_add_u32 s30, s28, s29
    v_add_u32 v7, s30, v4
    s_nop 4
    ds_write_b128 v6, v[52:55] offset:0
    ds_write_b128 v6, v[56:59] offset:8192
    ds_write_b128 v6, v[60:63] offset:16384
    ds_write_b128 v6, v[64:67] offset:24576
    ds_write_b128 v6, v[68:71] offset:32768
    ds_write_b128 v7, v[72:75] offset:0
    ds_write_b128 v7, v[76:79] offset:8192
    ds_write_b128 v7, v[80:83] offset:16384
    ds_write_b128 v7, v[84:87] offset:24576
    ds_write_b128 v7, v[88:91] offset:32768
    v_lshrrev_b32 v8, 2, v2
    v_lshl_add_u32 v8, v3, 3, v8
    v_lshlrev_b32 v8, 6, v8
    v_and_b32 v9, 3, v2
    v_lshl_add_u32 v8, v9, 3, v8
    s_movk_i32 s28, 1280
    v_lshlrev_b32 v9, 4, v3
    v_mad_u32_u24 v9, v2, s28, v9
    s_mov_b32 s40, s26
    s_waitcnt lgkmcnt(0)
    s_barrier
L_2_unit:
    s_and_b32 s28, s40, 1
    s_lshr_b32 s29, s40, 1
    s_lshl_b32 s30, s29, 14
    s_lshl_b32 s31, s28, 12
    s_add_u32 s30, s30, s31
    v_add_u32 v10, s30, v4
    ds_read_b128 v[196:199], v10 offset:0
    ds_read_b128 v[200:203], v10 offset:1024
    ds_read_b128 v[204:207], v10 offset:2048
    ds_read_b128 v[208:211], v10 offset:3072
    ds_read_b128 v[212:215], v10 offset:8192
    ds_read_b128 v[216:219], v10 offset:9216
    ds_read_b128 v[220:223], v10 offset:10240
    ds_read_b128 v[224:227], v10 offset:11264
    s_lshl_b32 s30, s29, 11
    s_lshl_b32 s31, s28, 5
    s_add_u32 s30, s30, s31
    s_add_u32 s30, s30, 122880
    v_add_u32 v11, s30, v8
    ds_read_b64_tr_b16 v[28:29], v11
    ds_read_b64_tr_b16 v[30:31], v11 offset:256
    s_cmp_eq_u32 s28, 1
    s_cselect_b64 s[32:33], -1, 0
    v_cndmask_b32 v44, v26, v27, s[32:33]
    v_sub_f32 v45, 1.0, v44
    v_cvt_pk_bf16_f32 v45, v45, v45
    v_lshlrev_b32 v45, 16, v45
    s_lshl_b32 s30, s24, 1
    s_add_u32 s30, s30, s28
    s_mul_i32 s30, s30, 20480
    s_mul_i32 s31, s25, 320
    s_add_u32 s30, s30, s31
    s_lshl_b32 s31, s29, 6
    s_add_u32 s30, s30, s31
    s_waitcnt lgkmcnt(0)
    v_lshlrev_b32 v32, 16, v28
    v_and_b32 v33, s36, v28
    v_lshlrev_b32 v34, 16, v29
    v_and_b32 v35, s36, v29
    v_lshlrev_b32 v36, 16, v30
    v_and_b32 v37, s36, v30
    v_lshlrev_b32 v38, 16, v31
    v_and_b32 v39, s36, v31
    v_mul_f32 v32, v32, v44
    v_mul_f32 v33, v33, v44
    v_mul_f32 v34, v34, v44
    v_mul_f32 v35, v35, v44
    v_mul_f32 v36, v36, v44
    v_mul_f32 v37, v37, v44
    v_mul_f32 v38, v38, v44
    v_mul_f32 v39, v39, v44
    v_cvt_pk_bf16_f32 v12, v32, v33
    v_cvt_pk_bf16_f32 v13, v34, v35
    v_cvt_pk_bf16_f32 v14, v36, v37
    v_cvt_pk_bf16_f32 v15, v38, v39
    v_lshlrev_b32 v32, 16, v12
    v_and_b32 v33, s36, v12
    v_lshlrev_b32 v34, 16, v13
    v_and_b32 v35, s36, v13
    v_lshlrev_b32 v36, 16, v14
    v_and_b32 v37, s36, v14
    v_lshlrev_b32 v38, 16, v15
    v_and_b32 v39, s36, v15
    v_pk_add_f32 v[196:197], v[196:197], v[200:201]
    v_pk_add_f32 v[204:205], v[204:205], v[208:209]
    v_pk_add_f32 v[198:199], v[198:199], v[202:203]
    v_pk_add_f32 v[206:207], v[206:207], v[210:211]
    v_pk_add_f32 v[212:213], v[212:213], v[216:217]
    v_pk_add_f32 v[220:221], v[220:221], v[224:225]
    v_pk_add_f32 v[214:215], v[214:215], v[218:219]
    v_pk_add_f32 v[222:223], v[222:223], v[226:227]
    v_pk_add_f32 v[196:197], v[196:197], v[204:205]
    v_pk_add_f32 v[198:199], v[198:199], v[206:207]
    v_pk_add_f32 v[212:213], v[212:213], v[220:221]
    v_pk_add_f32 v[214:215], v[214:215], v[222:223]
    v_cvt_pk_bf16_f32 v12, v196, v197
    v_cvt_pk_bf16_f32 v13, v198, v199
    v_cvt_pk_bf16_f32 v14, v212, v213
    v_cvt_pk_bf16_f32 v15, v214, v215
    v_lshlrev_b32 v196, 16, v12
    v_and_b32 v197, s36, v12
    v_lshlrev_b32 v198, 16, v13
    v_and_b32 v199, s36, v13
    v_lshlrev_b32 v212, 16, v14
    v_and_b32 v213, s36, v14
    v_lshlrev_b32 v214, 16, v15
    v_and_b32 v215, s36, v15
    v_mul_f32 v196, v196, v45
    v_mul_f32 v197, v197, v45
    v_mul_f32 v198, v198, v45
    v_mul_f32 v199, v199, v45
    v_mul_f32 v212, v212, v45
    v_mul_f32 v213, v213, v45
    v_mul_f32 v214, v214, v45
    v_mul_f32 v215, v215, v45
    v_cvt_pk_bf16_f32 v12, v196, v197
    v_cvt_pk_bf16_f32 v13, v198, v199
    v_cvt_pk_bf16_f32 v14, v212, v213
    v_cvt_pk_bf16_f32 v15, v214, v215
    v_lshlrev_b32 v196, 16, v12
    v_and_b32 v197, s36, v12
    v_lshlrev_b32 v198, 16, v13
    v_and_b32 v199, s36, v13
    v_lshlrev_b32 v212, 16, v14
    v_and_b32 v213, s36, v14
    v_lshlrev_b32 v214, 16, v15
    v_and_b32 v215, s36, v15
    v_pk_add_f32 v[196:197], v[196:197], v[32:33]
    v_pk_add_f32 v[198:199], v[198:199], v[34:35]
    v_pk_add_f32 v[212:213], v[212:213], v[36:37]
    v_pk_add_f32 v[214:215], v[214:215], v[38:39]
    v_cvt_pk_bf16_f32 v40, v196, v197
    v_cvt_pk_bf16_f32 v41, v198, v199
    v_cvt_pk_bf16_f32 v42, v212, v213
    v_cvt_pk_bf16_f32 v43, v214, v215
    buffer_store_dwordx4 v[40:43], v9, s[4:7], s30 offen sc1
    s_add_u32 s40, s40, 8
    s_cmp_lt_u32 s40, 10
    s_cbranch_scc1 L_2_unit
L_2_done:
    s_endpgm
.section .rodata,"a"
.p2align 6
.amdhsa_kernel gated_mix__ssm_conv_s4__linear_attn_block__prompt_kernel
  .amdhsa_next_free_vgpr 252
  .amdhsa_next_free_sgpr 72
  .amdhsa_accum_offset 252
  .amdhsa_group_segment_fixed_size 0
  .amdhsa_kernarg_size 128
  .amdhsa_user_sgpr_count 2
  .amdhsa_user_sgpr_kernarg_segment_ptr 1
  .amdhsa_system_sgpr_workgroup_id_x 1
.end_amdhsa_kernel
.p2align 6
.amdhsa_kernel attn_out_kernel
  .amdhsa_next_free_vgpr 256
  .amdhsa_next_free_sgpr 64
  .amdhsa_accum_offset 256
  .amdhsa_group_segment_fixed_size 0
  .amdhsa_kernarg_size 128
  .amdhsa_user_sgpr_count 2
  .amdhsa_user_sgpr_kernarg_segment_ptr 1
  .amdhsa_system_sgpr_workgroup_id_x 1
.end_amdhsa_kernel
```
